```python
import torch

def _softmax(x, axis=-1):
    return torch.softmax(x, dim=axis)
def _gelu(x):
    return torch.nn.functional.gelu(x, approximate="tanh")
def _silu(x):
    return torch.nn.functional.silu(x)
def _sigmoid(x):
    return torch.sigmoid(x)
def _layernorm(x, axis=-1, eps=1e-5):
    m = x.mean(dim=axis, keepdim=True)
    v = x.var(dim=axis, keepdim=True, unbiased=False)
    return (x - m) / torch.sqrt(v + eps)
def _scatter_add(tgt, idx, src, axis=0):
    return tgt.clone().index_add_(axis, idx, src)
def _segment_sum(src, seg, n):
    out = torch.zeros((n,) + src.shape[1:], dtype=src.dtype)
    return out.index_add_(0, seg, src)
def _pad(x, pw):
    flat = tuple(v for pair in reversed(pw) for v in pair)
    return torch.nn.functional.pad(x, flat)

kernel_name = 'concat_heads__sliding_block_cached__compressed_kv_cla__decode'

def setup_inputs():

    _w = (lambda a: (lambda t: t.to(torch.bfloat16) if t.is_floating_point() else t)(torch.as_tensor(a)))
    def _A_setup():
        B, Sq, D = 2, 1, 576
        Hq, Hkv, Sk, Dh = 32, 16, 8192, 128
        assert Hq % Hkv == 0, (Hq, Hkv)
        return {
            "x": _w((lambda *s: torch.randn(*s, dtype=torch.bfloat16) * 1.6)(B, Sq, D)),
            "k_cache": _w((lambda *s: torch.randn(*s, dtype=torch.bfloat16) * 1.6)(B, Hkv, Sk, Dh)),
            "v_cache": _w((lambda *s: torch.randn(*s, dtype=torch.bfloat16) * 0.05)(B, Hkv, Sk, Dh)),
            "wq": _w((lambda *s: torch.randn(*s, dtype=torch.bfloat16) * 1.6)(D, Hq * Dh) * (D ** -0.5)),
            "wo": _w((lambda *s: torch.randn(*s, dtype=torch.bfloat16) * 0.05)(Hq * Dh, D) * ((Hq * Dh) ** -0.5)),
        }
    _A_in = _A_setup()

    def _B_setup():
        B, H, Sq, Sk, D, M = 2, 32, 1, 8192, 128, 576
        Dc = 4 * D
        return {
            "x": _w((lambda *s: torch.randn(*s, dtype=torch.bfloat16) * 3.2)(B, Sq, M)),
            "c_kv": _w((lambda *s: torch.randn(*s, dtype=torch.bfloat16) * 0.1)(B, Sk, Dc)),
            "w_q": _w((lambda *s: torch.randn(*s, dtype=torch.bfloat16) * 6.4)(M, H, D) * (M ** -0.5)),
            "w_uk": _w((lambda *s: torch.randn(*s, dtype=torch.bfloat16) * 6.4)(Dc, H, D) * (Dc ** -0.5)),
            "w_uv": _w((lambda *s: torch.randn(*s, dtype=torch.bfloat16) * 0.1)(Dc, H, D) * (Dc ** -0.5)),
            "w_o": _w((lambda *s: torch.randn(*s, dtype=torch.bfloat16) * 0.1)(H, D, M) * ((H * D) ** -0.5)),
        }
    _B_in = _B_setup()

    return {
        "A_x": _A_in["x"],
        "A_k_cache": _A_in["k_cache"],
        "A_v_cache": _A_in["v_cache"],
        "A_wq": _A_in["wq"],
        "A_wo": _A_in["wo"],
        "B_x": _B_in["x"],
        "B_c_kv": _B_in["c_kv"],
        "B_w_q": _B_in["w_q"],
        "B_w_uk": _B_in["w_uk"],
        "B_w_uv": _B_in["w_uv"],
        "B_w_o": _B_in["w_o"],
    }

def reference(A_x, A_k_cache, A_v_cache, A_wq, A_wo, B_x, B_c_kv, B_w_q, B_w_uk, B_w_uv, B_w_o):
    def _A_ref(x, k_cache, v_cache, wq, wo):
        B, Sq, D = x.shape
        Hq, Dh = 32, 128
        Hkv, Sk = k_cache.shape[1], k_cache.shape[2]
        W = min(4096, max(256, Sk // 4))
        rep = Hq // Hkv
        q = (lambda x, *d: x.permute(*d))((x @ wq).reshape(B, Sq, Hq, Dh), 0, 2, 1, 3)
        k = (lambda x, n, axis: torch.repeat_interleave(x, n, dim=axis))(k_cache[:, :, Sk - W:, :], rep, axis=1)
        v = (lambda x, n, axis: torch.repeat_interleave(x, n, dim=axis))(v_cache[:, :, Sk - W:, :], rep, axis=1)
        scores = torch.einsum("bhqd,bhkd->bhqk", q, k) * (Dh ** -0.5)
        p = _softmax(scores, axis=-1)
        o = torch.einsum("bhqk,bhkd->bhqd", p, v)
        return (lambda x, *d: x.permute(*d))(o, 0, 2, 1, 3).reshape(B, Sq, Hq * Dh) @ wo

    def _B_ref(x, c_kv, w_q, w_uk, w_uv, w_o):
        B, Sq, M = x.shape[0], x.shape[1], x.shape[2]
        Sk = c_kv.shape[1]
        H, D = w_q.shape[1], w_q.shape[2]
        q = torch.einsum("bqm,mhd->bhqd", x, w_q)
        k = torch.einsum("bkc,chd->bhkd", c_kv, w_uk)
        v = torch.einsum("bkc,chd->bhkd", c_kv, w_uv)
        scores = torch.einsum("bhqd,bhkd->bhqk", q, k) * (D ** -0.5)
        off = Sk - Sq
        qi = torch.arange(Sq)[:, None]
        kj = torch.arange(Sk)[None, :]
        cmask = kj <= (qi + off)
        scores = torch.where(cmask[None, None], scores, -1e9)
        p = _softmax(scores, axis=-1)
        ctx = torch.einsum("bhqk,bhkd->bhqd", p, v)
        return torch.einsum("bhqd,hdm->bqm", ctx, w_o)

    a = _A_ref(A_x, A_k_cache, A_v_cache, A_wq, A_wo)
    b = _B_ref(B_x, B_c_kv, B_w_q, B_w_uk, B_w_uv, B_w_o)
    return torch.concatenate([a, b], axis=-1)
```

```asm
; @launch grid=(256,1,1) block=(512,1,1) lds=163840
.amdgcn_target "amdgcn-amd-amdhsa--gfx950"
.text
.globl concat_heads__sliding_block_cached__compressed_kv_cla__decode_kernel
.p2align 8
.type concat_heads__sliding_block_cached__compressed_kv_cla__decode_kernel,@function
concat_heads__sliding_block_cached__compressed_kv_cla__decode_kernel:
    s_cmp_ge_u32 s2, 256
    s_cbranch_scc1 L_EXIT
    s_load_dwordx16 s[16:31], s[0:1], 0
    s_load_dwordx8 s[32:39], s[0:1], 64
    s_load_dwordx4 s[40:43], s[0:1], 96
    v_lshrrev_b32 v5, 6, v0
    v_and_b32 v1, 63, v0
    v_readfirstlane_b32 s3, v5
    v_lshrrev_b32 v2, 4, v1
    v_and_b32 v3, 15, v1
    v_bfe_u32 v4, v3, 2, 1
    s_and_b32 s94, s2, 7
    s_lshr_b32 s95, s2, 3
    s_and_b32 s5, s95, 1
    s_lshr_b32 s95, s95, 1
    s_lshl_b32 s4, s94, 4
    s_add_u32 s4, s4, s95
    s_lshr_b32 s6, s4, 2
    s_and_b32 s7, s4, 3
    s_cmp_eq_u32 s5, 0
    s_cselect_b32 s79, 6, 4
    s_mov_b32 s12, 0x05040100
    s_mov_b32 s13, 0x07060302
    s_mov_b32 s14, 0x3e0293ee
    v_lshlrev_b32 v5, 15, v2
    v_lshl_add_u32 v5, v3, 4, v5
    v_mul_u32_u24 v6, 1152, v4
    v_lshl_add_u32 v6, v2, 3, v6
    s_waitcnt lgkmcnt(0)
    s_load_dword s8, s[42:43], 655360
    s_mov_b64 s[88:89], s[42:43]
    s_mov_b32 s0, 0xaaaaaaaa
    s_mov_b32 s1, 0xaaaaaaaa
    s_mov_b32 s90, 0xcccccccc
    s_mov_b32 s91, 0xcccccccc
    s_cmp_eq_u32 s5, 0
    s_cselect_b32 s44, s26, s16
    s_cselect_b32 s45, s27, s17
    s_mov_b32 s46, 2304
    s_and_b32 s45, s45, 0xffff
    s_mov_b32 s47, 0x20000
    s_cmp_eq_u32 s5, 0
    s_cselect_b32 s48, s30, s22
    s_cselect_b32 s49, s31, s23
    s_mov_b32 s50, 4718592
    s_and_b32 s49, s49, 0xffff
    s_mov_b32 s51, 0x20000
    s_cmp_lg_u32 s3, 0
    s_cbranch_scc1 LX_1
    s_mul_i32 s92, s7, 144
    s_add_u32 s92, s92, 128
    s_lshl_b32 s93, s92, 1
    buffer_load_dwordx2 v[18:19], v6, s[44:47], s93 offen
    s_lshl_b32 s92, s92, 13
    s_add_u32 s93, s6, s79
    s_and_b32 s93, s93, 31
    s_lshl_b32 s93, s93, 8
    s_add_u32 s92, s92, s93
    buffer_load_dwordx4 v[36:39], v5, s[48:51], s92 offen nt
    s_add_u32 s92, s92, 8192
    buffer_load_dwordx4 v[40:43], v5, s[48:51], s92 offen nt
    s_add_u32 s92, s92, 8192
    buffer_load_dwordx4 v[44:47], v5, s[48:51], s92 offen nt
    s_add_u32 s92, s92, 8192
    buffer_load_dwordx4 v[48:51], v5, s[48:51], s92 offen nt
LX_1:
    s_mul_i32 s92, s7, 144
    s_lshl_b32 s93, s3, 4
    s_add_u32 s92, s92, s93
    s_lshl_b32 s93, s92, 1
    buffer_load_dwordx2 v[16:17], v6, s[44:47], s93 offen
    s_lshl_b32 s92, s92, 13
    s_add_u32 s93, s6, s79
    s_and_b32 s93, s93, 31
    s_lshl_b32 s93, s93, 8
    s_add_u32 s92, s92, s93
    buffer_load_dwordx4 v[20:23], v5, s[48:51], s92 offen nt
    s_add_u32 s92, s92, 8192
    buffer_load_dwordx4 v[24:27], v5, s[48:51], s92 offen nt
    s_add_u32 s92, s92, 8192
    buffer_load_dwordx4 v[28:31], v5, s[48:51], s92 offen nt
    s_add_u32 s92, s92, 8192
    buffer_load_dwordx4 v[32:35], v5, s[48:51], s92 offen nt
    s_mov_b32 s80, s42
    s_and_b32 s81, s43, 0xffff
    s_mov_b32 s82, 268435456
    s_mov_b32 s83, 0x20000
    s_cmp_eq_u32 s5, 0
    s_cselect_b32 s52, s18, s28
    s_cselect_b32 s53, s19, s29
    s_mov_b32 s54, 16777216
    s_cselect_b32 s54, 67108864, s54
    s_and_b32 s53, s53, 0xffff
    s_mov_b32 s55, 0x20000
    s_cmp_eq_u32 s5, 0
    s_cselect_b32 s56, s20, s34
    s_cselect_b32 s57, s21, s35
    s_mov_b32 s58, 4194304
    s_cselect_b32 s58, 67108864, s58
    s_and_b32 s57, s57, 0xffff
    s_mov_b32 s59, 0x20000
    s_mov_b32 s64, s32
    s_and_b32 s65, s33, 0xffff
    s_mov_b32 s66, 4194304
    s_mov_b32 s67, 0x20000
    s_cmp_eq_u32 s5, 0
    s_cselect_b32 s60, s24, s36
    s_cselect_b32 s61, s25, s37
    s_mov_b32 s62, 4718592
    s_and_b32 s61, s61, 0xffff
    s_mov_b32 s63, 0x20000
    s_mov_b32 s84, s38
    s_and_b32 s85, s39, 0xffff
    s_mov_b32 s86, 4608
    s_mov_b32 s87, 0x20000
    s_cmp_eq_u32 s5, 0
    s_cbranch_scc0 L_Y0
    s_lshr_b32 s11, s4, 3
    s_bfe_u32 s9, s4, 0x10002
    s_and_b32 s10, s4, 3
    s_lshl_b32 s100, s9, 4
    s_add_u32 s100, s100, s11
    s_lshl_b32 s100, s100, 13
    s_lshl_b32 s101, s10, 9
    s_add_u32 s100, s100, s101
    s_add_u32 s100, s100, 6144
    s_lshl_b32 s100, s100, 8
    s_lshl_b32 s101, s3, 14
    s_add_u32 s15, s100, s101
    s_barrier
    v_lshlrev_b32 v7, 13, v3
    v_lshl_add_u32 v7, v2, 4, v7
    s_lshl_b32 s92, s7, 7
    s_lshl_b32 s93, s3, 4
    s_add_u32 s92, s92, s93
    s_lshl_b32 s92, s92, 13
    s_lshl_b32 s93, s6, 8
    s_add_u32 s92, s92, s93
    buffer_load_dwordx4 v[100:103], v7, s[64:67], s92 offen offset:0 nt
    buffer_load_dwordx4 v[104:107], v7, s[64:67], s92 offen offset:64 nt
    buffer_load_dwordx4 v[108:111], v7, s[64:67], s92 offen offset:128 nt
    buffer_load_dwordx4 v[112:115], v7, s[64:67], s92 offen offset:192 nt
    s_add_u32 s96, s6, 32
    s_lshr_b32 s97, s3, 2
    s_lshl_b32 s96, s96, 3
    s_add_u32 s96, s96, s97
    s_and_b32 s97, s3, 3
    s_lshl_b32 s97, s97, 1
    s_add_u32 s96, s96, s97
    s_lshl_b32 s96, s96, 10
    v_and_b32 v7, 1, v2
    v_lshlrev_b32 v7, 9, v7
    v_lshl_add_u32 v7, v3, 5, v7
    s_lshl_b32 s92, s3, 10
    s_add_u32 s92, s92, 131072
    v_add_u32 v7, s92, v7
    s_lshl_b32 s101, s3, 8
    s_add_u32 s101, s101, 131072
    v_lshl_add_u32 v5, v1, 2, s101
    s_lshl_b32 s101, s3, 9
    v_lshl_add_u32 v6, v1, 3, s101
    s_lshl_b32 s93, s79, 2
    s_add_u32 s93, s93, s4
    s_and_b32 s93, s93, 127
    s_add_u32 s93, s93, 128
    s_lshl_b32 s93, s93, 11
    s_waitcnt vmcnt(4)
    v_perm_b32 v52, v24, v20, s12
    v_perm_b32 v54, v24, v20, s13
    v_perm_b32 v53, v32, v28, s12
    v_perm_b32 v55, v32, v28, s13
    v_perm_b32 v56, v25, v21, s12
    v_perm_b32 v58, v25, v21, s13
    v_perm_b32 v57, v33, v29, s12
    v_perm_b32 v59, v33, v29, s13
    v_perm_b32 v60, v26, v22, s12
    v_perm_b32 v62, v26, v22, s13
    v_perm_b32 v61, v34, v30, s12
    v_perm_b32 v63, v34, v30, s13
    v_perm_b32 v64, v27, v23, s12
    v_perm_b32 v66, v27, v23, s13
    v_perm_b32 v65, v35, v31, s12
    v_perm_b32 v67, v35, v31, s13
    v_mfma_f32_16x16x16_bf16 v[68:71], v[16:17], v[52:53], 0
    v_mfma_f32_16x16x16_bf16 v[72:75], v[16:17], v[54:55], 0
    v_mfma_f32_16x16x16_bf16 v[76:79], v[16:17], v[56:57], 0
    v_mfma_f32_16x16x16_bf16 v[80:83], v[16:17], v[58:59], 0
    v_mfma_f32_16x16x16_bf16 v[84:87], v[16:17], v[60:61], 0
    v_mfma_f32_16x16x16_bf16 v[88:91], v[16:17], v[62:63], 0
    v_mfma_f32_16x16x16_bf16 v[92:95], v[16:17], v[64:65], 0
    v_mfma_f32_16x16x16_bf16 v[96:99], v[16:17], v[66:67], 0
    s_cmp_lg_u32 s3, 0
    s_cbranch_scc1 LY_2
    v_perm_b32 v20, v40, v36, s12
    v_perm_b32 v22, v40, v36, s13
    v_perm_b32 v21, v48, v44, s12
    v_perm_b32 v23, v48, v44, s13
    v_perm_b32 v24, v41, v37, s12
    v_perm_b32 v26, v41, v37, s13
    v_perm_b32 v25, v49, v45, s12
    v_perm_b32 v27, v49, v45, s13
    v_perm_b32 v28, v42, v38, s12
    v_perm_b32 v30, v42, v38, s13
    v_perm_b32 v29, v50, v46, s12
    v_perm_b32 v31, v50, v46, s13
    v_perm_b32 v32, v43, v39, s12
    v_perm_b32 v34, v43, v39, s13
    v_perm_b32 v33, v51, v47, s12
    v_perm_b32 v35, v51, v47, s13
    v_mfma_f32_16x16x16_bf16 v[68:71], v[18:19], v[20:21], v[68:71]
    v_mfma_f32_16x16x16_bf16 v[72:75], v[18:19], v[22:23], v[72:75]
    v_mfma_f32_16x16x16_bf16 v[76:79], v[18:19], v[24:25], v[76:79]
    v_mfma_f32_16x16x16_bf16 v[80:83], v[18:19], v[26:27], v[80:83]
    v_mfma_f32_16x16x16_bf16 v[84:87], v[18:19], v[28:29], v[84:87]
    v_mfma_f32_16x16x16_bf16 v[88:91], v[18:19], v[30:31], v[88:91]
    v_mfma_f32_16x16x16_bf16 v[92:95], v[18:19], v[32:33], v[92:95]
    v_mfma_f32_16x16x16_bf16 v[96:99], v[18:19], v[34:35], v[96:99]
LY_2:
    s_nop 1
    ds_write2_b32 v7, v68, v72 offset0:0 offset1:1
    s_nop 0
    ds_write2_b32 v7, v76, v80 offset0:2 offset1:3
    s_nop 0
    ds_write2_b32 v7, v84, v88 offset0:4 offset1:5
    s_nop 0
    ds_write2_b32 v7, v92, v96 offset0:6 offset1:7
    s_waitcnt lgkmcnt(0)
    s_barrier
    s_add_u32 s8, s8, 0x9e3779b9
    s_cmp_ge_u32 s3, 4
    s_cbranch_scc1 LZ_3
    ds_read_b32 v20, v5 offset:0
    ds_read_b32 v21, v5 offset:1024
    ds_read_b32 v22, v5 offset:2048
    ds_read_b32 v23, v5 offset:3072
    ds_read_b32 v24, v5 offset:4096
    ds_read_b32 v25, v5 offset:5120
    ds_read_b32 v26, v5 offset:6144
    ds_read_b32 v27, v5 offset:7168
    v_mov_b32 v29, s8
    s_waitcnt lgkmcnt(0)
    v_add_f32 v20, v20, v21
    v_add_f32 v22, v22, v23
    v_add_f32 v24, v24, v25
    v_add_f32 v26, v26, v27
    v_add_f32 v20, v20, v22
    v_add_f32 v24, v24, v26
    v_add_f32 v28, v20, v24
    buffer_store_dwordx2 v[28:29], v6, s[80:83], s93 offen sc0 sc1
LZ_3:
    s_lshr_b32 s98, s4, 3
    s_lshl_b32 s98, s98, 1
    s_lshr_b32 s99, s3, 2
    s_add_u32 s98, s98, s99
    s_bfe_u32 s99, s4, 0x10002
    s_lshl_b32 s98, s98, 3
    s_add_u32 s98, s98, s99
    s_and_b32 s99, s3, 3
    s_lshl_b32 s99, s99, 1
    s_add_u32 s98, s98, s99
    s_lshl_b32 s98, s98, 10
    s_add_u32 s97, s96, 1016
    s_mov_b32 s5, 0
SP_4:
    s_load_dwordx2 s[16:17], s[88:89], s97 glc
    s_waitcnt lgkmcnt(0)
    s_cmp_eq_u32 s17, s8
    s_cbranch_scc1 SD_5
    s_add_u32 s5, s5, 1
    s_cmp_lt_u32 s5, 300000
    s_cbranch_scc1 SP_4
SD_5:
    v_lshlrev_b32 v5, 4, v1
    buffer_load_dwordx4 v[8:11], v5, s[80:83], s96 offen sc0 sc1
    v_lshlrev_b32 v5, 4, v1
    buffer_load_dwordx4 v[240:243], v5, s[80:83], s98 offen sc0 sc1
    s_lshl_b32 s92, s3, 9
    s_add_u32 s92, s92, 139264
    v_lshlrev_b32 v6, 3, v1
    v_add_u32 v6, s92, v6
    s_mov_b32 s5, 0
    s_waitcnt vmcnt(1)
RC_6:
    v_cmp_eq_u32 vcc, s8, v9
    v_cmp_eq_u32 s[16:17], s8, v11
    s_nop 0
    s_and_b64 vcc, vcc, s[16:17]
    s_cmp_eq_u64 vcc, exec
    s_cbranch_scc1 RD_7
    s_add_u32 s5, s5, 1
    s_cmp_ge_u32 s5, 300000
    s_cbranch_scc1 RD_7
    v_lshlrev_b32 v5, 4, v1
    buffer_load_dwordx4 v[8:11], v5, s[80:83], s96 offen sc0 sc1
    s_waitcnt vmcnt(0)
    s_branch RC_6
RD_7:
    ds_write2_b32 v6, v8, v10 offset0:0 offset1:1
    s_lshl_b32 s92, s3, 11
    s_add_u32 s92, s92, 139264
    v_lshlrev_b32 v5, 3, v1
    v_add_u32 v5, s92, v5
    s_lshl_b32 s92, s3, 8
    s_add_u32 s92, s92, 143360
    v_lshlrev_b32 v6, 2, v1
    v_add_u32 v6, s92, v6
    s_waitcnt lgkmcnt(0)
    s_barrier
    s_cmp_ge_u32 s3, 2
    s_cbranch_scc1 LQ_8
    ds_read_b64 v[8:9], v5 offset:0
    ds_read_b64 v[10:11], v5 offset:512
    ds_read_b64 v[12:13], v5 offset:1024
    ds_read_b64 v[14:15], v5 offset:1536
    s_waitcnt lgkmcnt(0)
    v_add_f32 v8, v8, v10
    v_add_f32 v9, v9, v11
    v_add_f32 v12, v12, v14
    v_add_f32 v13, v13, v15
    v_add_f32 v8, v8, v12
    v_add_f32 v9, v9, v13
    v_cvt_pk_bf16_f32 v8, v8, v9
    ds_write_b32 v6, v8
LQ_8:
    v_lshlrev_b32 v5, 8, v4
    v_lshl_add_u32 v5, v2, 4, v5
    v_add_u32 v5, 143360, v5
    s_waitcnt lgkmcnt(0)
    s_barrier
    ds_read_b128 v[16:19], v5 offset:0
    ds_read_b128 v[20:23], v5 offset:64
    ds_read_b128 v[24:27], v5 offset:128
    ds_read_b128 v[28:31], v5 offset:192
    v_and_b32 v5, 1, v2
    v_lshlrev_b32 v6, 8, v5
    v_lshl_add_u32 v7, v3, 4, v6
    v_add_u32 v7, 143872, v7
    v_lshl_add_u32 v6, v3, 1, v6
    s_lshl_b32 s92, s3, 5
    s_add_u32 s92, s92, 143872
    v_add_u32 v6, s92, v6
    v_lshlrev_b32 v14, 15, v5
    v_lshl_add_u32 v14, v3, 4, v14
    v_lshlrev_b32 v15, 10, v5
    v_lshl_add_u32 v15, v3, 11, v15
    s_lshl_b32 s92, s4, 8
    s_add_u32 s92, s92, 524288
    s_lshl_b32 s93, s4, 3
    s_add_u32 s93, s93, 589824
    s_waitcnt lgkmcnt(0)
    v_mfma_f32_16x16x32_bf16 v[32:35], v[16:19], v[100:103], 0
    v_mfma_f32_16x16x32_bf16 v[32:35], v[20:23], v[104:107], v[32:35]
    v_mfma_f32_16x16x32_bf16 v[32:35], v[24:27], v[108:111], v[32:35]
    v_mfma_f32_16x16x32_bf16 v[32:35], v[28:31], v[112:115], v[32:35]
    s_nop 7
    v_cvt_pk_bf16_f32 v8, v32, v32
    ds_write_b16 v6, v8
    s_waitcnt lgkmcnt(0)
    s_barrier
    s_cmp_lg_u32 s3, 0
    s_cbranch_scc1 BP_9
    ds_read_b128 v[8:11], v7
    v_mov_b32 v13, s8
    s_waitcnt lgkmcnt(0)
    s_mov_b32 exec_lo, 0xffffffff
    s_mov_b32 exec_hi, 0x00000000
    buffer_store_dwordx4 v[8:11], v14, s[80:83], s92 offen sc0 sc1
    s_mov_b64 exec, -1
    v_bitop3_b32 v12, v8, v9, v10 bitop3:0x96
    v_xor_b32 v12, v12, v11
    s_nop 1
    v_xor_b32_dpp v12, v12, v12 row_ror:8 row_mask:0xf bank_mask:0xf
    s_nop 1
    v_xor_b32_dpp v12, v12, v12 row_ror:4 row_mask:0xf bank_mask:0xf
    s_nop 1
    v_xor_b32_dpp v12, v12, v12 row_ror:2 row_mask:0xf bank_mask:0xf
    s_nop 1
    v_xor_b32_dpp v12, v12, v12 row_ror:1 row_mask:0xf bank_mask:0xf
    s_mov_b32 exec_lo, 0x00ff00ff
    s_mov_b32 exec_hi, 0x00000000
    buffer_store_dwordx2 v[12:13], v15, s[80:83], s93 offen sc0 sc1
    s_mov_b64 exec, -1
BP_9:
    s_barrier
    v_xor_b32 v248, v3, v2
    v_lshlrev_b32 v248, 4, v248
    v_lshl_add_u32 v248, v2, 8, v248
    v_xor_b32 v249, 64, v248
    v_xor_b32 v250, 128, v248
    v_xor_b32 v251, 192, v248
    s_lshl_b32 s92, s3, 14
    s_add_u32 m0, s92, 0
    s_add_u32 s93, s15, 0
    buffer_load_dwordx4 v248, s[52:55], s93 offen offset:0 nt lds
    buffer_load_dwordx4 v249, s[52:55], s93 offen offset:1024 nt lds
    buffer_load_dwordx4 v250, s[52:55], s93 offen offset:2048 nt lds
    buffer_load_dwordx4 v251, s[52:55], s93 offen offset:3072 nt lds
    s_add_u32 m0, s92, 4096
    s_add_u32 s93, s15, 4096
    buffer_load_dwordx4 v248, s[52:55], s93 offen offset:0 nt lds
    buffer_load_dwordx4 v249, s[52:55], s93 offen offset:1024 nt lds
    buffer_load_dwordx4 v250, s[52:55], s93 offen offset:2048 nt lds
    buffer_load_dwordx4 v251, s[52:55], s93 offen offset:3072 nt lds
    s_add_u32 m0, s92, 8192
    s_add_u32 s93, s15, 8192
    buffer_load_dwordx4 v248, s[52:55], s93 offen offset:0 nt lds
    buffer_load_dwordx4 v249, s[52:55], s93 offen offset:1024 nt lds
    buffer_load_dwordx4 v250, s[52:55], s93 offen offset:2048 nt lds
    buffer_load_dwordx4 v251, s[52:55], s93 offen offset:3072 nt lds
    s_add_u32 m0, s92, 12288
    s_add_u32 s93, s15, 12288
    buffer_load_dwordx4 v248, s[52:55], s93 offen offset:0 nt lds
    buffer_load_dwordx4 v249, s[52:55], s93 offen offset:1024 nt lds
    buffer_load_dwordx4 v250, s[52:55], s93 offen offset:2048 nt lds
    buffer_load_dwordx4 v251, s[52:55], s93 offen offset:3072 nt lds
    s_lshl_b32 s92, s3, 9
    s_add_u32 s92, s92, 139264
    v_lshlrev_b32 v6, 3, v1
    v_add_u32 v6, s92, v6
    s_mov_b32 s5, 0
    s_waitcnt vmcnt(16)
RC_10:
    v_cmp_eq_u32 vcc, s8, v241
    v_cmp_eq_u32 s[16:17], s8, v243
    s_nop 0
    s_and_b64 vcc, vcc, s[16:17]
    s_cmp_eq_u64 vcc, exec
    s_cbranch_scc1 RD_11
    s_add_u32 s5, s5, 1
    s_cmp_ge_u32 s5, 300000
    s_cbranch_scc1 RD_11
    v_lshlrev_b32 v5, 4, v1
    buffer_load_dwordx4 v[240:243], v5, s[80:83], s98 offen sc0 sc1
    s_waitcnt vmcnt(0)
    s_branch RC_10
RD_11:
    ds_write2_b32 v6, v240, v242 offset0:0 offset1:1
    s_lshl_b32 s92, s3, 11
    s_add_u32 s92, s92, 139264
    v_lshlrev_b32 v5, 3, v1
    v_add_u32 v5, s92, v5
    s_lshl_b32 s92, s3, 8
    s_add_u32 s92, s92, 143360
    v_lshlrev_b32 v6, 2, v1
    v_add_u32 v6, s92, v6
    s_waitcnt lgkmcnt(0)
    s_barrier
    s_cmp_ge_u32 s3, 2
    s_cbranch_scc1 LQ_12
    ds_read_b64 v[8:9], v5 offset:0
    ds_read_b64 v[10:11], v5 offset:512
    ds_read_b64 v[12:13], v5 offset:1024
    ds_read_b64 v[14:15], v5 offset:1536
    s_waitcnt lgkmcnt(0)
    v_add_f32 v8, v8, v10
    v_add_f32 v9, v9, v11
    v_add_f32 v12, v12, v14
    v_add_f32 v13, v13, v15
    v_add_f32 v8, v8, v12
    v_add_f32 v9, v9, v13
    v_cvt_pk_bf16_f32 v8, v8, v9
    ds_write_b32 v6, v8
LQ_12:
    v_lshlrev_b32 v5, 8, v4
    v_lshl_add_u32 v5, v2, 4, v5
    v_add_u32 v5, 143360, v5
    s_waitcnt lgkmcnt(0)
    s_barrier
    ds_read_b128 v[16:19], v5 offset:0
    ds_read_b128 v[20:23], v5 offset:64
    ds_read_b128 v[24:27], v5 offset:128
    ds_read_b128 v[28:31], v5 offset:192
    v_lshlrev_b32 v6, 10, v2
    v_lshl_add_u32 v6, v3, 4, v6
    s_add_u32 s92, s15, 0
    buffer_load_dwordx4 v[96:99], v6, s[56:59], s92 offen offset:0 nt
    buffer_load_dwordx4 v[100:103], v6, s[56:59], s92 offen offset:256 nt
    buffer_load_dwordx4 v[104:107], v6, s[56:59], s92 offen offset:512 nt
    buffer_load_dwordx4 v[108:111], v6, s[56:59], s92 offen offset:768 nt
    s_add_u32 s92, s15, 4096
    buffer_load_dwordx4 v[112:115], v6, s[56:59], s92 offen offset:0 nt
    buffer_load_dwordx4 v[116:119], v6, s[56:59], s92 offen offset:256 nt
    buffer_load_dwordx4 v[120:123], v6, s[56:59], s92 offen offset:512 nt
    buffer_load_dwordx4 v[124:127], v6, s[56:59], s92 offen offset:768 nt
    s_add_u32 s92, s15, 8192
    buffer_load_dwordx4 v[128:131], v6, s[56:59], s92 offen offset:0 nt
    buffer_load_dwordx4 v[132:135], v6, s[56:59], s92 offen offset:256 nt
    buffer_load_dwordx4 v[136:139], v6, s[56:59], s92 offen offset:512 nt
    buffer_load_dwordx4 v[140:143], v6, s[56:59], s92 offen offset:768 nt
    s_add_u32 s92, s15, 12288
    buffer_load_dwordx4 v[144:147], v6, s[56:59], s92 offen offset:0 nt
    buffer_load_dwordx4 v[148:151], v6, s[56:59], s92 offen offset:256 nt
    buffer_load_dwordx4 v[152:155], v6, s[56:59], s92 offen offset:512 nt
    buffer_load_dwordx4 v[156:159], v6, s[56:59], s92 offen offset:768 nt
    v_add_u32 v160, 0, v1
    v_mul_u32_u24 v5, 3641, v160
    v_lshrrev_b32 v5, 16, v5
    v_lshlrev_b32 v160, 4, v160
    v_mul_u32_u24 v5, 864, v5
    v_add_u32 v160, v160, v5
    v_add_u32 v161, 64, v1
    v_mul_u32_u24 v5, 3641, v161
    v_lshrrev_b32 v5, 16, v5
    v_lshlrev_b32 v161, 4, v161
    v_mul_u32_u24 v5, 864, v5
    v_add_u32 v161, v161, v5
    v_add_u32 v162, 128, v1
    v_mul_u32_u24 v5, 3641, v162
    v_lshrrev_b32 v5, 16, v5
    v_lshlrev_b32 v162, 4, v162
    v_mul_u32_u24 v5, 864, v5
    v_add_u32 v162, v162, v5
    v_add_u32 v163, 192, v1
    v_mul_u32_u24 v5, 3641, v163
    v_lshrrev_b32 v5, 16, v5
    v_lshlrev_b32 v163, 4, v163
    v_mul_u32_u24 v5, 864, v5
    v_add_u32 v163, v163, v5
    v_add_u32 v164, 256, v1
    v_mul_u32_u24 v5, 3641, v164
    v_lshrrev_b32 v5, 16, v5
    v_lshlrev_b32 v164, 4, v164
    v_mul_u32_u24 v5, 864, v5
    v_add_u32 v164, v164, v5
    s_waitcnt vmcnt(16)
    v_xor_b32 v5, v3, v2
    v_lshlrev_b32 v5, 4, v5
    v_lshl_add_u32 v5, v3, 8, v5
    s_lshl_b32 s92, s3, 14
    v_add_u32 v5, s92, v5
    v_xor_b32 v6, 64, v5
    v_xor_b32 v7, 128, v5
    v_xor_b32 v8, 192, v5
    ds_read_b128 v[32:35], v5 offset:0
    ds_read_b128 v[36:39], v6 offset:0
    ds_read_b128 v[40:43], v7 offset:0
    ds_read_b128 v[44:47], v8 offset:0
    ds_read_b128 v[48:51], v5 offset:4096
    ds_read_b128 v[52:55], v6 offset:4096
    ds_read_b128 v[56:59], v7 offset:4096
    ds_read_b128 v[60:63], v8 offset:4096
    s_waitcnt lgkmcnt(4)
    v_mfma_f32_16x16x32_bf16 v[64:67], v[32:35], v[16:19], 0
    v_mfma_f32_16x16x32_bf16 v[64:67], v[36:39], v[20:23], v[64:67]
    v_mfma_f32_16x16x32_bf16 v[64:67], v[40:43], v[24:27], v[64:67]
    v_mfma_f32_16x16x32_bf16 v[64:67], v[44:47], v[28:31], v[64:67]
    ds_read_b128 v[32:35], v5 offset:8192
    ds_read_b128 v[36:39], v6 offset:8192
    ds_read_b128 v[40:43], v7 offset:8192
    ds_read_b128 v[44:47], v8 offset:8192
    s_waitcnt lgkmcnt(4)
    v_mfma_f32_16x16x32_bf16 v[68:71], v[48:51], v[16:19], 0
    v_mfma_f32_16x16x32_bf16 v[68:71], v[52:55], v[20:23], v[68:71]
    v_mfma_f32_16x16x32_bf16 v[68:71], v[56:59], v[24:27], v[68:71]
    v_mfma_f32_16x16x32_bf16 v[68:71], v[60:63], v[28:31], v[68:71]
    ds_read_b128 v[48:51], v5 offset:12288
    ds_read_b128 v[52:55], v6 offset:12288
    ds_read_b128 v[56:59], v7 offset:12288
    ds_read_b128 v[60:63], v8 offset:12288
    s_waitcnt lgkmcnt(4)
    v_mfma_f32_16x16x32_bf16 v[72:75], v[32:35], v[16:19], 0
    v_mfma_f32_16x16x32_bf16 v[72:75], v[36:39], v[20:23], v[72:75]
    v_mfma_f32_16x16x32_bf16 v[72:75], v[40:43], v[24:27], v[72:75]
    v_mfma_f32_16x16x32_bf16 v[72:75], v[44:47], v[28:31], v[72:75]
    s_waitcnt lgkmcnt(0)
    v_mfma_f32_16x16x32_bf16 v[76:79], v[48:51], v[16:19], 0
    v_mfma_f32_16x16x32_bf16 v[76:79], v[52:55], v[20:23], v[76:79]
    v_mfma_f32_16x16x32_bf16 v[76:79], v[56:59], v[24:27], v[76:79]
    v_mfma_f32_16x16x32_bf16 v[76:79], v[60:63], v[28:31], v[76:79]
    s_add_u32 s92, s6, 4
    s_and_b32 s92, s92, 31
    s_lshl_b32 s92, s92, 7
    s_lshl_b32 s93, s3, 4
    s_add_u32 s92, s92, s93
    s_mul_i32 s92, s92, 1152
    s_mul_i32 s93, s7, 288
    s_add_u32 s92, s92, s93
    s_mul_i32 s93, s3, 16384
    s_add_u32 m0, s93, 0
    s_nop 0
    buffer_load_dwordx4 v160, s[60:63], s92 offen nt lds
    s_add_u32 m0, s93, 1024
    s_nop 0
    buffer_load_dwordx4 v161, s[60:63], s92 offen nt lds
    s_add_u32 m0, s93, 2048
    s_nop 0
    buffer_load_dwordx4 v162, s[60:63], s92 offen nt lds
    s_add_u32 m0, s93, 3072
    s_nop 0
    buffer_load_dwordx4 v163, s[60:63], s92 offen nt lds
    s_add_u32 m0, s93, 4096
    s_mov_b32 exec_lo, 0xffffffff
    s_mov_b32 exec_hi, 0x00000000
    buffer_load_dwordx4 v164, s[60:63], s92 offen nt lds
    s_mov_b64 exec, -1
    v_max3_f32 v10, v64, v65, v66
    v_max3_f32 v10, v10, v67, v68
    v_max3_f32 v10, v10, v69, v70
    v_max3_f32 v10, v10, v71, v72
    v_max3_f32 v10, v10, v73, v74
    v_max3_f32 v10, v10, v75, v76
    v_max3_f32 v10, v10, v77, v78
    v_max_f32 v10, v10, v79
    v_mov_b32 v12, v10
    s_nop 1
    v_permlane16_swap_b32 v10, v12
    v_max_f32 v10, v10, v12
    v_mov_b32 v12, v10
    s_nop 1
    v_permlane32_swap_b32 v10, v12
    v_max_f32 v10, v10, v12
    v_mul_f32 v10, s14, v10
    v_fma_f32 v64, v64, s14, -v10
    v_fma_f32 v65, v65, s14, -v10
    v_fma_f32 v66, v66, s14, -v10
    v_fma_f32 v67, v67, s14, -v10
    v_fma_f32 v68, v68, s14, -v10
    v_fma_f32 v69, v69, s14, -v10
    v_fma_f32 v70, v70, s14, -v10
    v_fma_f32 v71, v71, s14, -v10
    v_fma_f32 v72, v72, s14, -v10
    v_fma_f32 v73, v73, s14, -v10
    v_fma_f32 v74, v74, s14, -v10
    v_fma_f32 v75, v75, s14, -v10
    v_fma_f32 v76, v76, s14, -v10
    v_fma_f32 v77, v77, s14, -v10
    v_fma_f32 v78, v78, s14, -v10
    v_fma_f32 v79, v79, s14, -v10
    v_exp_f32 v64, v64
    v_exp_f32 v65, v65
    v_exp_f32 v66, v66
    v_exp_f32 v67, v67
    v_exp_f32 v68, v68
    v_exp_f32 v69, v69
    v_exp_f32 v70, v70
    v_exp_f32 v71, v71
    v_exp_f32 v72, v72
    v_exp_f32 v73, v73
    v_exp_f32 v74, v74
    v_exp_f32 v75, v75
    v_exp_f32 v76, v76
    v_exp_f32 v77, v77
    v_exp_f32 v78, v78
    v_exp_f32 v79, v79
    v_cvt_pk_bf16_f32 v32, v64, v65
    v_cvt_pk_bf16_f32 v33, v66, v67
    v_cvt_pk_bf16_f32 v34, v68, v69
    v_cvt_pk_bf16_f32 v35, v70, v71
    v_cvt_pk_bf16_f32 v36, v72, v73
    v_cvt_pk_bf16_f32 v37, v74, v75
    v_cvt_pk_bf16_f32 v38, v76, v77
    v_cvt_pk_bf16_f32 v39, v78, v79
    v_add_f32 v64, v64, v65
    v_add_f32 v66, v66, v67
    v_add_f32 v68, v68, v69
    v_add_f32 v70, v70, v71
    v_add_f32 v72, v72, v73
    v_add_f32 v74, v74, v75
    v_add_f32 v76, v76, v77
    v_add_f32 v78, v78, v79
    v_add_f32 v64, v64, v66
    v_add_f32 v68, v68, v70
    v_add_f32 v72, v72, v74
    v_add_f32 v76, v76, v78
    v_add_f32 v64, v64, v68
    v_add_f32 v72, v72, v76
    v_add_f32 v11, v64, v72
    v_mov_b32 v12, v11
    s_nop 1
    v_permlane16_swap_b32 v11, v12
    v_add_f32 v11, v11, v12
    v_mov_b32 v12, v11
    s_nop 1
    v_permlane32_swap_b32 v11, v12
    v_add_f32 v11, v11, v12
    s_lshl_b32 s92, s3, 4
    s_add_u32 s92, s92, 139264
    v_lshlrev_b32 v5, 3, v4
    v_add_u32 v5, s92, v5
    ds_write_b64 v5, v[10:11]
    v_and_b32 v7, 1, v2
    v_lshlrev_b32 v7, 9, v7
    v_lshl_add_u32 v7, v3, 5, v7
    s_lshl_b32 s92, s3, 10
    s_add_u32 s92, s92, 131072
    v_add_u32 v7, s92, v7
    s_and_b32 s92, s3, 1
    s_lshl_b32 s93, s92, 9
    s_add_u32 s93, s93, 131072
    v_lshl_add_u32 v5, v1, 3, s93
    s_lshl_b32 s93, s92, 3
    s_add_u32 s93, s93, 139264
    v_mov_b32 v6, s93
    s_lshl_b32 s94, s11, 1
    s_add_u32 s94, s94, s92
    s_lshl_b32 s95, s94, 2
    s_add_u32 s95, s95, s10
    s_lshl_b32 s95, s95, 1
    s_add_u32 s95, s95, s9
    s_lshl_b32 s95, s95, 10
    s_add_u32 s95, s95, 1048576
    v_lshlrev_b32 v8, 4, v1
    s_waitcnt vmcnt(13)
    v_perm_b32 v192, v100, v96, s12
    v_perm_b32 v196, v100, v96, s13
    v_perm_b32 v193, v108, v104, s12
    v_perm_b32 v197, v108, v104, s13
    v_perm_b32 v194, v116, v112, s12
    v_perm_b32 v198, v116, v112, s13
    v_perm_b32 v195, v124, v120, s12
    v_perm_b32 v199, v124, v120, s13
    v_perm_b32 v200, v101, v97, s12
    v_perm_b32 v204, v101, v97, s13
    v_perm_b32 v201, v109, v105, s12
    v_perm_b32 v205, v109, v105, s13
    v_perm_b32 v202, v117, v113, s12
    v_perm_b32 v206, v117, v113, s13
    v_perm_b32 v203, v125, v121, s12
    v_perm_b32 v207, v125, v121, s13
    v_perm_b32 v208, v102, v98, s12
    v_perm_b32 v212, v102, v98, s13
    v_perm_b32 v209, v110, v106, s12
    v_perm_b32 v213, v110, v106, s13
    v_perm_b32 v210, v118, v114, s12
    v_perm_b32 v214, v118, v114, s13
    v_perm_b32 v211, v126, v122, s12
    v_perm_b32 v215, v126, v122, s13
    v_perm_b32 v216, v103, v99, s12
    v_perm_b32 v220, v103, v99, s13
    v_perm_b32 v217, v111, v107, s12
    v_perm_b32 v221, v111, v107, s13
    v_perm_b32 v218, v119, v115, s12
    v_perm_b32 v222, v119, v115, s13
    v_perm_b32 v219, v127, v123, s12
    v_perm_b32 v223, v127, v123, s13
    v_mfma_f32_16x16x32_bf16 v[224:227], v[32:35], v[192:195], 0
    v_mfma_f32_16x16x32_bf16 v[228:231], v[32:35], v[196:199], 0
    v_mfma_f32_16x16x32_bf16 v[232:235], v[32:35], v[200:203], 0
    v_mfma_f32_16x16x32_bf16 v[236:239], v[32:35], v[204:207], 0
    v_mfma_f32_16x16x32_bf16 v[240:243], v[32:35], v[208:211], 0
    v_mfma_f32_16x16x32_bf16 v[244:247], v[32:35], v[212:215], 0
    v_mfma_f32_16x16x32_bf16 v[248:251], v[32:35], v[216:219], 0
    v_mfma_f32_16x16x32_bf16 v[252:255], v[32:35], v[220:223], 0
    s_waitcnt vmcnt(5)
    v_perm_b32 v192, v132, v128, s12
    v_perm_b32 v196, v132, v128, s13
    v_perm_b32 v193, v140, v136, s12
    v_perm_b32 v197, v140, v136, s13
    v_perm_b32 v194, v148, v144, s12
    v_perm_b32 v198, v148, v144, s13
    v_perm_b32 v195, v156, v152, s12
    v_perm_b32 v199, v156, v152, s13
    v_perm_b32 v200, v133, v129, s12
    v_perm_b32 v204, v133, v129, s13
    v_perm_b32 v201, v141, v137, s12
    v_perm_b32 v205, v141, v137, s13
    v_perm_b32 v202, v149, v145, s12
    v_perm_b32 v206, v149, v145, s13
    v_perm_b32 v203, v157, v153, s12
    v_perm_b32 v207, v157, v153, s13
    v_perm_b32 v208, v134, v130, s12
    v_perm_b32 v212, v134, v130, s13
    v_perm_b32 v209, v142, v138, s12
    v_perm_b32 v213, v142, v138, s13
    v_perm_b32 v210, v150, v146, s12
    v_perm_b32 v214, v150, v146, s13
    v_perm_b32 v211, v158, v154, s12
    v_perm_b32 v215, v158, v154, s13
    v_perm_b32 v216, v135, v131, s12
    v_perm_b32 v220, v135, v131, s13
    v_perm_b32 v217, v143, v139, s12
    v_perm_b32 v221, v143, v139, s13
    v_perm_b32 v218, v151, v147, s12
    v_perm_b32 v222, v151, v147, s13
    v_perm_b32 v219, v159, v155, s12
    v_perm_b32 v223, v159, v155, s13
    v_mfma_f32_16x16x32_bf16 v[224:227], v[36:39], v[192:195], v[224:227]
    v_mfma_f32_16x16x32_bf16 v[228:231], v[36:39], v[196:199], v[228:231]
    v_mfma_f32_16x16x32_bf16 v[232:235], v[36:39], v[200:203], v[232:235]
    v_mfma_f32_16x16x32_bf16 v[236:239], v[36:39], v[204:207], v[236:239]
    v_mfma_f32_16x16x32_bf16 v[240:243], v[36:39], v[208:211], v[240:243]
    v_mfma_f32_16x16x32_bf16 v[244:247], v[36:39], v[212:215], v[244:247]
    v_mfma_f32_16x16x32_bf16 v[248:251], v[36:39], v[216:219], v[248:251]
    v_mfma_f32_16x16x32_bf16 v[252:255], v[36:39], v[220:223], v[252:255]
    s_nop 1
    ds_write2_b32 v7, v224, v228 offset0:0 offset1:1
    s_nop 0
    ds_write2_b32 v7, v232, v236 offset0:2 offset1:3
    s_nop 0
    ds_write2_b32 v7, v240, v244 offset0:4 offset1:5
    s_nop 0
    ds_write2_b32 v7, v248, v252 offset0:6 offset1:7
    s_waitcnt lgkmcnt(0)
    s_barrier
    s_cmp_ge_u32 s3, 2
    s_cbranch_scc1 AZ_13
    ds_read_b64 v[32:33], v6 offset:0
    ds_read_b64 v[34:35], v6 offset:16
    ds_read_b64 v[36:37], v6 offset:32
    ds_read_b64 v[38:39], v6 offset:48
    ds_read_b64 v[40:41], v6 offset:64
    ds_read_b64 v[42:43], v6 offset:80
    ds_read_b64 v[44:45], v6 offset:96
    ds_read_b64 v[46:47], v6 offset:112
    ds_read_b64 v[48:49], v5 offset:0
    ds_read_b64 v[50:51], v5 offset:1024
    ds_read_b64 v[52:53], v5 offset:2048
    ds_read_b64 v[54:55], v5 offset:3072
    ds_read_b64 v[56:57], v5 offset:4096
    ds_read_b64 v[58:59], v5 offset:5120
    ds_read_b64 v[60:61], v5 offset:6144
    ds_read_b64 v[62:63], v5 offset:7168
    v_mov_b32 v19, s8
    s_waitcnt lgkmcnt(8)
    v_max3_f32 v20, v32, v34, v36
    v_max3_f32 v20, v20, v38, v40
    v_max3_f32 v20, v20, v42, v44
    v_max_f32 v20, v20, v46
    v_sub_f32 v32, v32, v20
    v_sub_f32 v34, v34, v20
    v_sub_f32 v36, v36, v20
    v_sub_f32 v38, v38, v20
    v_sub_f32 v40, v40, v20
    v_sub_f32 v42, v42, v20
    v_sub_f32 v44, v44, v20
    v_sub_f32 v46, v46, v20
    v_exp_f32 v32, v32
    v_exp_f32 v34, v34
    v_exp_f32 v36, v36
    v_exp_f32 v38, v38
    v_exp_f32 v40, v40
    v_exp_f32 v42, v42
    v_exp_f32 v44, v44
    v_exp_f32 v46, v46
    v_mul_f32 v21, v33, v32
    v_fmac_f32 v21, v35, v34
    v_fmac_f32 v21, v37, v36
    v_fmac_f32 v21, v39, v38
    v_fmac_f32 v21, v41, v40
    v_fmac_f32 v21, v43, v42
    v_fmac_f32 v21, v45, v44
    v_fmac_f32 v21, v47, v46
    v_cndmask_b32 v18, v20, v21, s[0:1]
    s_waitcnt lgkmcnt(0)
    v_mul_f32 v16, v48, v32
    v_mul_f32 v17, v49, v32
    v_fmac_f32 v16, v50, v34
    v_fmac_f32 v17, v51, v34
    v_fmac_f32 v16, v52, v36
    v_fmac_f32 v17, v53, v36
    v_fmac_f32 v16, v54, v38
    v_fmac_f32 v17, v55, v38
    v_fmac_f32 v16, v56, v40
    v_fmac_f32 v17, v57, v40
    v_fmac_f32 v16, v58, v42
    v_fmac_f32 v17, v59, v42
    v_fmac_f32 v16, v60, v44
    v_fmac_f32 v17, v61, v44
    v_fmac_f32 v16, v62, v46
    v_fmac_f32 v17, v63, v46
    buffer_store_dwordx4 v[16:19], v8, s[80:83], s95 offen sc0 sc1
    s_waitcnt vmcnt(1)
    s_branch AZ_14
AZ_13:
    s_waitcnt vmcnt(0)
AZ_14:
    s_barrier
    v_lshrrev_b32 v14, 2, v3
    v_lshlrev_b32 v14, 11, v14
    v_and_b32 v15, 1, v3
    v_lshl_add_u32 v14, v15, 10, v14
    v_lshl_add_u32 v14, v2, 5, v14
    v_and_b32 v13, 2, v3
    v_lshl_add_u32 v14, v13, 3, v14
    s_add_u32 s97, s6, 4
    s_and_b32 s97, s97, 31
    s_add_u32 s96, s97, 0
    s_lshl_b32 s96, s96, 13
    s_lshl_b32 s94, s3, 7
    s_add_u32 s96, s96, s94
    s_add_u32 s96, s96, 1048576
    buffer_load_dwordx4 v[48:51], v14, s[80:83], s96 offen sc0 sc1
    v_lshrrev_b32 v5, 1, v2
    v_mul_u32_u24 v5, 16384, v5
    v_and_b32 v6, 1, v2
    v_lshlrev_b32 v6, 3, v6
    v_lshrrev_b32 v7, 2, v3
    v_add_u32 v6, v6, v7
    v_mul_u32_u24 v6, 288, v6
    v_add_u32 v5, v5, v6
    v_and_b32 v6, 3, v3
    v_lshl_add_u32 v5, v6, 3, v5
    s_lshl_b32 s92, s3, 5
    s_add_u32 s92, s92, 0
    v_add_u32 v5, s92, v5
    v_add_u32 v6, 65536, v5
    ds_read_b64_tr_b16 v[132:133], v5 offset:0
    ds_read_b64_tr_b16 v[134:135], v5 offset:1152
    ds_read_b64_tr_b16 v[136:137], v5 offset:32768
    ds_read_b64_tr_b16 v[138:139], v5 offset:33920
    ds_read_b64_tr_b16 v[140:141], v6 offset:0
    ds_read_b64_tr_b16 v[142:143], v6 offset:1152
    ds_read_b64_tr_b16 v[144:145], v6 offset:32768
    ds_read_b64_tr_b16 v[146:147], v6 offset:33920
    s_cmp_lg_u32 s3, 0
    s_cbranch_scc1 WX_15
    ds_read_b64_tr_b16 v[148:149], v5 offset:256
    ds_read_b64_tr_b16 v[150:151], v5 offset:1408
    ds_read_b64_tr_b16 v[152:153], v5 offset:33024
    ds_read_b64_tr_b16 v[154:155], v5 offset:34176
    ds_read_b64_tr_b16 v[156:157], v6 offset:256
    ds_read_b64_tr_b16 v[158:159], v6 offset:1408
    ds_read_b64_tr_b16 v[160:161], v6 offset:33024
    ds_read_b64_tr_b16 v[162:163], v6 offset:34176
WX_15:
    v_lshlrev_b32 v7, 8, v15
    v_lshl_add_u32 v7, v2, 3, v7
    v_lshl_add_u32 v7, v13, 1, v7
    s_lshl_b32 s94, s3, 5
    s_add_u32 s94, s94, 144384
    v_add_u32 v7, s94, v7
    v_and_b32 v6, 1, v3
    v_lshlrev_b32 v6, 8, v6
    v_lshl_add_u32 v6, v2, 4, v6
    v_add_u32 v6, 144384, v6
    v_mul_u32_u24 v15, 147456, v15
    v_lshrrev_b32 v13, 1, v3
    v_lshl_add_u32 v15, v13, 4, v15
    s_mul_i32 s98, s7, 36864
    s_lshl_b32 s94, s97, 7
    s_add_u32 s98, s98, s94
    s_add_u32 s98, s98, 6291456
    s_add_u32 s99, s98, 32768
    s_lshl_b32 s94, s3, 12
    s_add_u32 s98, s98, s94
    v_mov_b32 v105, s8
    v_mov_b32 v107, s8
    v_mov_b32 v109, s8
    v_mov_b32 v111, s8
    s_mov_b32 s5, 0
    s_waitcnt vmcnt(0)
RC_16:
    v_cmp_eq_u32 vcc, s8, v51
    s_nop 0
    s_cmp_eq_u64 vcc, exec
    s_cbranch_scc1 RD_17
    s_add_u32 s5, s5, 1
    s_cmp_ge_u32 s5, 300000
    s_cbranch_scc1 RD_17
    s_sleep 1
    buffer_load_dwordx4 v[48:51], v14, s[80:83], s96 offen sc0 sc1
    s_waitcnt vmcnt(0)
    s_branch RC_16
RD_17:
    v_mov_b32_dpp v9, v50 quad_perm:[2,3,0,1] row_mask:0xf bank_mask:0xf
    v_cndmask_b32 v8, v50, v9, s[90:91]
    v_cndmask_b32 v9, v9, v50, s[90:91]
    s_nop 0
    v_max_f32_dpp v10, v8, v8 row_ror:4 row_mask:0xf bank_mask:0xf
    s_nop 1
    v_max_f32_dpp v10, v10, v10 row_ror:8 row_mask:0xf bank_mask:0xf
    v_sub_f32 v8, v8, v10
    v_exp_f32 v8, v8
    s_nop 0
    v_mul_f32 v9, v8, v9
    v_mul_f32 v10, v8, v48
    v_mul_f32 v11, v8, v49
    v_add_f32_dpp v9, v9, v9 row_ror:4 row_mask:0xf bank_mask:0xf
    v_add_f32_dpp v10, v10, v10 row_ror:4 row_mask:0xf bank_mask:0xf
    v_add_f32_dpp v11, v11, v11 row_ror:4 row_mask:0xf bank_mask:0xf
    v_add_f32_dpp v9, v9, v9 row_ror:8 row_mask:0xf bank_mask:0xf
    v_add_f32_dpp v10, v10, v10 row_ror:8 row_mask:0xf bank_mask:0xf
    v_add_f32_dpp v11, v11, v11 row_ror:8 row_mask:0xf bank_mask:0xf
    v_rcp_f32 v9, v9
    s_nop 0
    v_mul_f32 v10, v10, v9
    v_mul_f32 v11, v11, v9
    v_cvt_pk_bf16_f32 v10, v10, v11
    s_mov_b32 exec_lo, 0x000f000f
    s_mov_b32 exec_hi, 0x000f000f
    ds_write_b32 v7, v10
    s_mov_b64 exec, -1
    s_waitcnt lgkmcnt(0)
    s_barrier
    ds_read_b128 v[16:19], v6 offset:0
    ds_read_b128 v[20:23], v6 offset:64
    ds_read_b128 v[24:27], v6 offset:128
    ds_read_b128 v[28:31], v6 offset:192
    s_waitcnt lgkmcnt(0)
    v_mfma_f32_16x16x32_bf16 v[64:67], v[16:19], v[132:135], 0
    v_mfma_f32_16x16x32_bf16 v[64:67], v[20:23], v[136:139], v[64:67]
    v_mfma_f32_16x16x32_bf16 v[64:67], v[24:27], v[140:143], v[64:67]
    v_mfma_f32_16x16x32_bf16 v[64:67], v[28:31], v[144:147], v[64:67]
    s_cmp_lg_u32 s3, 0
    s_nop 5
    s_cbranch_scc1 TO_18
    v_mfma_f32_16x16x32_bf16 v[68:71], v[16:19], v[148:151], 0
    v_mfma_f32_16x16x32_bf16 v[68:71], v[20:23], v[152:155], v[68:71]
    v_mfma_f32_16x16x32_bf16 v[68:71], v[24:27], v[156:159], v[68:71]
    v_mfma_f32_16x16x32_bf16 v[68:71], v[28:31], v[160:163], v[68:71]
    s_nop 7
    v_mov_b32_dpp v12, v68 quad_perm:[1,0,3,2] row_mask:0xf bank_mask:0xf
    v_mov_b32_dpp v13, v69 quad_perm:[1,0,3,2] row_mask:0xf bank_mask:0xf
    v_cndmask_b32 v108, v68, v13, s[0:1]
    v_cndmask_b32 v110, v12, v69, s[0:1]
    s_mov_b32 exec_lo, 0x0000ffff
    s_mov_b32 exec_hi, 0x00000000
    buffer_store_dwordx4 v[108:111], v15, s[80:83], s99 offen sc0 sc1
    s_mov_b64 exec, -1
TO_18:
    v_mov_b32_dpp v12, v64 quad_perm:[1,0,3,2] row_mask:0xf bank_mask:0xf
    v_mov_b32_dpp v13, v65 quad_perm:[1,0,3,2] row_mask:0xf bank_mask:0xf
    v_cndmask_b32 v104, v64, v13, s[0:1]
    v_cndmask_b32 v106, v12, v65, s[0:1]
    s_mov_b32 exec_lo, 0x0000ffff
    s_mov_b32 exec_hi, 0x00000000
    buffer_store_dwordx4 v[104:107], v15, s[80:83], s98 offen sc0 sc1
    s_mov_b64 exec, -1
    s_cmp_ge_u32 s4, 72
    s_cbranch_scc1 L_END
    s_cmp_lg_u32 s3, 0
    s_cbranch_scc1 L_END
    s_lshl_b32 s96, s4, 12
    s_add_u32 s96, s96, 6291456
    s_cmp_ge_u32 s4, 36
    s_cselect_b32 s94, 1152, 0
    s_lshl_b32 s95, s4, 5
    s_add_u32 s94, s94, s95
    s_add_u32 s100, s94, 0
    v_lshlrev_b32 v5, 4, v1
    v_lshlrev_b32 v6, 2, v1
    buffer_load_dwordx4 v[16:19], v5, s[80:83], s96 offen offset:0 sc0 sc1
    buffer_load_dwordx4 v[20:23], v5, s[80:83], s96 offen offset:1024 sc0 sc1
    buffer_load_dwordx4 v[24:27], v5, s[80:83], s96 offen offset:2048 sc0 sc1
    buffer_load_dwordx4 v[28:31], v5, s[80:83], s96 offen offset:3072 sc0 sc1
    s_mov_b32 s5, 0
    s_sleep 10
    buffer_load_dwordx4 v[32:35], v5, s[80:83], s96 offen offset:0 sc0 sc1
    buffer_load_dwordx4 v[36:39], v5, s[80:83], s96 offen offset:1024 sc0 sc1
    buffer_load_dwordx4 v[40:43], v5, s[80:83], s96 offen offset:2048 sc0 sc1
    buffer_load_dwordx4 v[44:47], v5, s[80:83], s96 offen offset:3072 sc0 sc1
PP_19:
    s_waitcnt vmcnt(4)
    v_xor_b32 v8, s8, v17
    v_bitop3_b32 v8, v19, s8, v8 bitop3:0xbe
    v_bitop3_b32 v8, v21, s8, v8 bitop3:0xbe
    v_bitop3_b32 v8, v23, s8, v8 bitop3:0xbe
    v_bitop3_b32 v8, v25, s8, v8 bitop3:0xbe
    v_bitop3_b32 v8, v27, s8, v8 bitop3:0xbe
    v_bitop3_b32 v8, v29, s8, v8 bitop3:0xbe
    v_bitop3_b32 v8, v31, s8, v8 bitop3:0xbe
    v_cmp_eq_u32 vcc, 0, v8
    s_nop 0
    s_cmp_eq_u64 vcc, exec
    s_cbranch_scc1 PD_20
    buffer_load_dwordx4 v[16:19], v5, s[80:83], s96 offen offset:0 sc0 sc1
    buffer_load_dwordx4 v[20:23], v5, s[80:83], s96 offen offset:1024 sc0 sc1
    buffer_load_dwordx4 v[24:27], v5, s[80:83], s96 offen offset:2048 sc0 sc1
    buffer_load_dwordx4 v[28:31], v5, s[80:83], s96 offen offset:3072 sc0 sc1
    s_waitcnt vmcnt(4)
    v_xor_b32 v8, s8, v33
    v_bitop3_b32 v8, v35, s8, v8 bitop3:0xbe
    v_bitop3_b32 v8, v37, s8, v8 bitop3:0xbe
    v_bitop3_b32 v8, v39, s8, v8 bitop3:0xbe
    v_bitop3_b32 v8, v41, s8, v8 bitop3:0xbe
    v_bitop3_b32 v8, v43, s8, v8 bitop3:0xbe
    v_bitop3_b32 v8, v45, s8, v8 bitop3:0xbe
    v_bitop3_b32 v8, v47, s8, v8 bitop3:0xbe
    v_cmp_eq_u32 vcc, 0, v8
    s_nop 0
    s_cmp_eq_u64 vcc, exec
    s_cbranch_scc1 PD_21
    buffer_load_dwordx4 v[32:35], v5, s[80:83], s96 offen offset:0 sc0 sc1
    buffer_load_dwordx4 v[36:39], v5, s[80:83], s96 offen offset:1024 sc0 sc1
    buffer_load_dwordx4 v[40:43], v5, s[80:83], s96 offen offset:2048 sc0 sc1
    buffer_load_dwordx4 v[44:47], v5, s[80:83], s96 offen offset:3072 sc0 sc1
    s_add_u32 s5, s5, 1
    s_cmp_lt_u32 s5, 300000
    s_cbranch_scc1 PP_19
    s_waitcnt vmcnt(0)
PD_20:
    v_add_f32 v10, v16, v20
    v_add_f32 v11, v24, v28
    v_add_f32 v12, v18, v22
    v_add_f32 v13, v26, v30
    v_add_f32 v14, v10, v11
    v_add_f32 v15, v12, v13
    s_branch PE_22
PD_21:
    v_add_f32 v10, v32, v36
    v_add_f32 v11, v40, v44
    v_add_f32 v12, v34, v38
    v_add_f32 v13, v42, v46
    v_add_f32 v14, v10, v11
    v_add_f32 v15, v12, v13
PE_22:
    s_nop 0
    v_add_f32_dpp v14, v14, v14 row_ror:8 row_mask:0xf bank_mask:0xf
    v_add_f32_dpp v15, v15, v15 row_ror:8 row_mask:0xf bank_mask:0xf
    v_mov_b32 v8, v14
    v_mov_b32 v9, v15
    s_nop 0
    v_permlane16_swap_b32 v14, v8
    v_permlane16_swap_b32 v15, v9
    v_add_f32 v14, v14, v8
    v_add_f32 v15, v15, v9
    v_mov_b32 v8, v14
    v_mov_b32 v9, v15
    s_nop 0
    v_permlane32_swap_b32 v14, v8
    v_permlane32_swap_b32 v15, v9
    v_add_f32 v14, v14, v8
    v_add_f32 v15, v15, v9
    v_cvt_pk_bf16_f32 v14, v14, v15
    s_mov_b32 exec_lo, 0x000000ff
    s_mov_b32 exec_hi, 0x00000000
    buffer_store_dword v14, v6, s[84:87], s100 offen
    s_cmp_lg_u32 s4, 0
    s_cbranch_scc1 EP_23
    v_mov_b32 v5, 655360
    v_mov_b32 v6, s8
    s_mov_b32 exec_lo, 0x00000001
    s_mov_b32 exec_hi, 0x00000000
    buffer_store_dword v6, v5, s[80:83], 0 offen sc0 sc1
EP_23:
    s_mov_b64 exec, -1
    s_waitcnt vmcnt(0)
    s_branch L_END
L_Y0:
    s_lshr_b32 s9, s4, 6
    s_and_b32 s10, s4, 63
    s_lshl_b32 s100, s4, 17
    s_lshl_b32 s101, s3, 14
    s_add_u32 s15, s100, s101
    s_barrier
    v_lshlrev_b32 v248, 4, v1
    s_lshl_b32 s92, s3, 14
    v_xor_b32 v249, 0, v248
    s_add_u32 m0, s92, 0
    s_add_u32 s93, s15, 0
    buffer_load_dwordx4 v249, s[52:55], s93 offen nt lds
    v_xor_b32 v249, 64, v248
    s_add_u32 m0, s92, 1024
    s_add_u32 s93, s15, 1024
    buffer_load_dwordx4 v249, s[52:55], s93 offen nt lds
    v_xor_b32 v249, 128, v248
    s_add_u32 m0, s92, 2048
    s_add_u32 s93, s15, 2048
    buffer_load_dwordx4 v249, s[52:55], s93 offen nt lds
    v_xor_b32 v249, 192, v248
    s_add_u32 m0, s92, 3072
    s_add_u32 s93, s15, 3072
    buffer_load_dwordx4 v249, s[52:55], s93 offen nt lds
    v_and_b32 v7, 1, v2
    v_lshlrev_b32 v7, 9, v7
    v_lshl_add_u32 v7, v3, 5, v7
    s_lshl_b32 s92, s3, 10
    s_add_u32 s92, s92, 131072
    v_add_u32 v7, s92, v7
    s_lshl_b32 s101, s3, 8
    s_add_u32 s101, s101, 131072
    v_lshl_add_u32 v5, v1, 2, s101
    s_lshl_b32 s101, s3, 9
    v_lshl_add_u32 v6, v1, 3, s101
    s_lshl_b32 s93, s79, 2
    s_add_u32 s93, s93, s4
    s_and_b32 s93, s93, 127
    s_add_u32 s93, s93, 0
    s_lshl_b32 s93, s93, 11
    s_waitcnt vmcnt(4)
    v_perm_b32 v52, v24, v20, s12
    v_perm_b32 v54, v24, v20, s13
    v_perm_b32 v53, v32, v28, s12
    v_perm_b32 v55, v32, v28, s13
    v_perm_b32 v56, v25, v21, s12
    v_perm_b32 v58, v25, v21, s13
    v_perm_b32 v57, v33, v29, s12
    v_perm_b32 v59, v33, v29, s13
    v_perm_b32 v60, v26, v22, s12
    v_perm_b32 v62, v26, v22, s13
    v_perm_b32 v61, v34, v30, s12
    v_perm_b32 v63, v34, v30, s13
    v_perm_b32 v64, v27, v23, s12
    v_perm_b32 v66, v27, v23, s13
    v_perm_b32 v65, v35, v31, s12
    v_perm_b32 v67, v35, v31, s13
    v_mfma_f32_16x16x16_bf16 v[68:71], v[16:17], v[52:53], 0
    v_mfma_f32_16x16x16_bf16 v[72:75], v[16:17], v[54:55], 0
    v_mfma_f32_16x16x16_bf16 v[76:79], v[16:17], v[56:57], 0
    v_mfma_f32_16x16x16_bf16 v[80:83], v[16:17], v[58:59], 0
    v_mfma_f32_16x16x16_bf16 v[84:87], v[16:17], v[60:61], 0
    v_mfma_f32_16x16x16_bf16 v[88:91], v[16:17], v[62:63], 0
    v_mfma_f32_16x16x16_bf16 v[92:95], v[16:17], v[64:65], 0
    v_mfma_f32_16x16x16_bf16 v[96:99], v[16:17], v[66:67], 0
    s_cmp_lg_u32 s3, 0
    s_cbranch_scc1 LY_24
    v_perm_b32 v20, v40, v36, s12
    v_perm_b32 v22, v40, v36, s13
    v_perm_b32 v21, v48, v44, s12
    v_perm_b32 v23, v48, v44, s13
    v_perm_b32 v24, v41, v37, s12
    v_perm_b32 v26, v41, v37, s13
    v_perm_b32 v25, v49, v45, s12
    v_perm_b32 v27, v49, v45, s13
    v_perm_b32 v28, v42, v38, s12
    v_perm_b32 v30, v42, v38, s13
    v_perm_b32 v29, v50, v46, s12
    v_perm_b32 v31, v50, v46, s13
    v_perm_b32 v32, v43, v39, s12
    v_perm_b32 v34, v43, v39, s13
    v_perm_b32 v33, v51, v47, s12
    v_perm_b32 v35, v51, v47, s13
    v_mfma_f32_16x16x16_bf16 v[68:71], v[18:19], v[20:21], v[68:71]
    v_mfma_f32_16x16x16_bf16 v[72:75], v[18:19], v[22:23], v[72:75]
    v_mfma_f32_16x16x16_bf16 v[76:79], v[18:19], v[24:25], v[76:79]
    v_mfma_f32_16x16x16_bf16 v[80:83], v[18:19], v[26:27], v[80:83]
    v_mfma_f32_16x16x16_bf16 v[84:87], v[18:19], v[28:29], v[84:87]
    v_mfma_f32_16x16x16_bf16 v[88:91], v[18:19], v[30:31], v[88:91]
    v_mfma_f32_16x16x16_bf16 v[92:95], v[18:19], v[32:33], v[92:95]
    v_mfma_f32_16x16x16_bf16 v[96:99], v[18:19], v[34:35], v[96:99]
LY_24:
    s_nop 1
    ds_write2_b32 v7, v68, v72 offset0:0 offset1:1
    s_nop 0
    ds_write2_b32 v7, v76, v80 offset0:2 offset1:3
    s_nop 0
    ds_write2_b32 v7, v84, v88 offset0:4 offset1:5
    s_nop 0
    ds_write2_b32 v7, v92, v96 offset0:6 offset1:7
    s_waitcnt lgkmcnt(0)
    s_barrier
    s_add_u32 s8, s8, 0x9e3779b9
    s_cmp_ge_u32 s3, 4
    s_cbranch_scc1 LZ_25
    ds_read_b32 v20, v5 offset:0
    ds_read_b32 v21, v5 offset:1024
    ds_read_b32 v22, v5 offset:2048
    ds_read_b32 v23, v5 offset:3072
    ds_read_b32 v24, v5 offset:4096
    ds_read_b32 v25, v5 offset:5120
    ds_read_b32 v26, v5 offset:6144
    ds_read_b32 v27, v5 offset:7168
    v_mov_b32 v29, s8
    s_waitcnt lgkmcnt(0)
    v_add_f32 v20, v20, v21
    v_add_f32 v22, v22, v23
    v_add_f32 v24, v24, v25
    v_add_f32 v26, v26, v27
    v_add_f32 v20, v20, v22
    v_add_f32 v24, v24, v26
    v_add_f32 v28, v20, v24
    buffer_store_dwordx2 v[28:29], v6, s[80:83], s93 offen sc0 sc1
LZ_25:
    v_lshlrev_b32 v248, 4, v1
    s_lshl_b32 s92, s3, 14
    v_xor_b32 v249, 16, v248
    s_add_u32 m0, s92, 4096
    s_add_u32 s93, s15, 4096
    buffer_load_dwordx4 v249, s[52:55], s93 offen nt lds
    v_xor_b32 v249, 80, v248
    s_add_u32 m0, s92, 5120
    s_add_u32 s93, s15, 5120
    buffer_load_dwordx4 v249, s[52:55], s93 offen nt lds
    v_xor_b32 v249, 144, v248
    s_add_u32 m0, s92, 6144
    s_add_u32 s93, s15, 6144
    buffer_load_dwordx4 v249, s[52:55], s93 offen nt lds
    v_xor_b32 v249, 208, v248
    s_add_u32 m0, s92, 7168
    s_add_u32 s93, s15, 7168
    buffer_load_dwordx4 v249, s[52:55], s93 offen nt lds
    v_xor_b32 v249, 32, v248
    s_add_u32 m0, s92, 8192
    s_add_u32 s93, s15, 8192
    buffer_load_dwordx4 v249, s[52:55], s93 offen nt lds
    v_xor_b32 v249, 96, v248
    s_add_u32 m0, s92, 9216
    s_add_u32 s93, s15, 9216
    buffer_load_dwordx4 v249, s[52:55], s93 offen nt lds
    v_xor_b32 v249, 160, v248
    s_add_u32 m0, s92, 10240
    s_add_u32 s93, s15, 10240
    buffer_load_dwordx4 v249, s[52:55], s93 offen nt lds
    v_xor_b32 v249, 224, v248
    s_add_u32 m0, s92, 11264
    s_add_u32 s93, s15, 11264
    buffer_load_dwordx4 v249, s[52:55], s93 offen nt lds
    v_xor_b32 v249, 48, v248
    s_add_u32 m0, s92, 12288
    s_add_u32 s93, s15, 12288
    buffer_load_dwordx4 v249, s[52:55], s93 offen nt lds
    v_xor_b32 v249, 112, v248
    s_add_u32 m0, s92, 13312
    s_add_u32 s93, s15, 13312
    buffer_load_dwordx4 v249, s[52:55], s93 offen nt lds
    v_xor_b32 v249, 176, v248
    s_add_u32 m0, s92, 14336
    s_add_u32 s93, s15, 14336
    buffer_load_dwordx4 v249, s[52:55], s93 offen nt lds
    v_xor_b32 v249, 240, v248
    s_add_u32 m0, s92, 15360
    s_add_u32 s93, s15, 15360
    buffer_load_dwordx4 v249, s[52:55], s93 offen nt lds
    s_lshl_b32 s92, s9, 10
    s_lshl_b32 s93, s3, 7
    s_add_u32 s92, s92, s93
    s_and_b32 s93, s10, 7
    s_lshl_b32 s93, s93, 11
    s_add_u32 s92, s92, s93
    s_add_u32 s97, s92, 589824
    s_lshl_b32 s96, s9, 15
    s_lshl_b32 s93, s3, 12
    s_add_u32 s96, s96, s93
    s_add_u32 s96, s96, 524288
    s_add_u32 s93, s97, 64
    s_mov_b32 s5, 0
SP_26:
    s_load_dwordx16 s[16:31], s[88:89], s97 glc
    s_load_dwordx16 s[32:47], s[88:89], s93 glc
    s_waitcnt lgkmcnt(0)
    s_xor_b32 s94, s17, s8
    s_xor_b32 s95, s19, s8
    s_or_b32 s94, s94, s95
    s_xor_b32 s95, s21, s8
    s_or_b32 s94, s94, s95
    s_xor_b32 s95, s23, s8
    s_or_b32 s94, s94, s95
    s_xor_b32 s95, s25, s8
    s_or_b32 s94, s94, s95
    s_xor_b32 s95, s27, s8
    s_or_b32 s94, s94, s95
    s_xor_b32 s95, s29, s8
    s_or_b32 s94, s94, s95
    s_xor_b32 s95, s31, s8
    s_or_b32 s94, s94, s95
    s_xor_b32 s95, s33, s8
    s_or_b32 s94, s94, s95
    s_xor_b32 s95, s35, s8
    s_or_b32 s94, s94, s95
    s_xor_b32 s95, s37, s8
    s_or_b32 s94, s94, s95
    s_xor_b32 s95, s39, s8
    s_or_b32 s94, s94, s95
    s_xor_b32 s95, s41, s8
    s_or_b32 s94, s94, s95
    s_xor_b32 s95, s43, s8
    s_or_b32 s94, s94, s95
    s_xor_b32 s95, s45, s8
    s_or_b32 s94, s94, s95
    s_xor_b32 s95, s47, s8
    s_or_b32 s94, s94, s95
    s_cmp_eq_u32 s94, 0
    s_cbranch_scc1 SD_27
    s_add_u32 s5, s5, 1
    s_cmp_lt_u32 s5, 300000
    s_cbranch_scc1 SP_26
SD_27:
    v_lshlrev_b32 v5, 4, v1
    buffer_load_dwordx4 v[16:19], v5, s[80:83], s96 offen offset:0
    buffer_load_dwordx4 v[20:23], v5, s[80:83], s96 offen offset:1024
    buffer_load_dwordx4 v[24:27], v5, s[80:83], s96 offen offset:2048
    buffer_load_dwordx4 v[28:31], v5, s[80:83], s96 offen offset:3072
    v_and_b32 v6, 3, v3
    v_lshlrev_b32 v6, 5, v6
    v_lshl_add_u32 v6, v2, 3, v6
    buffer_load_dwordx2 v[32:33], v6, s[80:83], s97 offen sc0 sc1
    v_and_b32 v8, 31, v1
    v_lshrrev_b32 v9, 5, v1
    s_and_b32 s98, s3, 3
    s_lshr_b32 s99, s3, 2
    v_and_b32 v5, 3, v8
    v_lshlrev_b32 v5, 2, v5
    v_bfe_u32 v6, v8, 2, 2
    v_or_b32 v5, v5, v6
    v_xor_b32 v5, v5, v9
    v_lshlrev_b32 v5, 4, v5
    v_lshl_add_u32 v5, v8, 10, v5
    s_lshl_b32 s94, s98, 15
    s_lshl_b32 s95, s99, 9
    s_add_u32 s94, s94, s95
    v_add_u32 v56, s94, v5
    v_xor_b32 v57, 32, v56
    v_xor_b32 v58, 64, v56
    v_xor_b32 v59, 96, v56
    v_xor_b32 v60, 128, v56
    v_xor_b32 v61, 160, v56
    v_xor_b32 v62, 192, v56
    v_xor_b32 v63, 224, v56
    v_lshrrev_b32 v5, 2, v3
    v_lshlrev_b32 v6, 2, v5
    v_or_b32 v6, v6, v9
    v_and_b32 v7, 1, v2
    v_lshlrev_b32 v7, 1, v7
    v_bfe_u32 v13, v3, 1, 1
    v_or_b32 v7, v7, v13
    s_and_b32 s94, s3, 1
    s_lshl_b32 s94, s94, 3
    v_or_b32 v7, s94, v7
    v_xor_b32 v6, v6, v7
    v_lshlrev_b32 v6, 4, v6
    v_and_b32 v7, 1, v3
    v_lshl_add_u32 v6, v7, 3, v6
    v_lshl_add_u32 v5, v9, 2, v5
    v_lshl_add_u32 v6, v5, 10, v6
    s_lshr_b32 s94, s3, 1
    s_lshl_b32 s94, s94, 8
    v_add_u32 v48, s94, v6
    v_xor_b32 v49, 64, v48
    v_xor_b32 v50, 32, v48
    v_add_u32 v50, 8192, v50
    v_xor_b32 v51, 64, v50
    v_add_u32 v52, 0x10000, v48
    v_add_u32 v53, 0x10000, v49
    v_add_u32 v54, 0x10000, v50
    v_add_u32 v55, 0x10000, v51
    s_waitcnt vmcnt(5)
    s_barrier
    ds_read_b128 v[64:67], v56 offset:0
    ds_read_b128 v[68:71], v57 offset:0
    ds_read_b128 v[72:75], v58 offset:0
    ds_read_b128 v[76:79], v59 offset:0
    ds_read_b128 v[80:83], v60 offset:0
    ds_read_b128 v[84:87], v61 offset:0
    ds_read_b128 v[88:91], v62 offset:0
    ds_read_b128 v[92:95], v63 offset:0
    ds_read_b128 v[96:99], v56 offset:256
    ds_read_b128 v[100:103], v57 offset:256
    ds_read_b128 v[104:107], v58 offset:256
    ds_read_b128 v[108:111], v59 offset:256
    ds_read_b128 v[112:115], v60 offset:256
    ds_read_b128 v[116:119], v61 offset:256
    ds_read_b128 v[120:123], v62 offset:256
    ds_read_b128 v[124:127], v63 offset:256
    ds_read_b64_tr_b16 v[128:129], v48 offset:0
    ds_read_b64_tr_b16 v[130:131], v50 offset:0
    ds_read_b64_tr_b16 v[132:133], v49 offset:0
    ds_read_b64_tr_b16 v[134:135], v51 offset:0
    ds_read_b64_tr_b16 v[136:137], v48 offset:16384
    ds_read_b64_tr_b16 v[138:139], v50 offset:16384
    ds_read_b64_tr_b16 v[140:141], v49 offset:16384
    ds_read_b64_tr_b16 v[142:143], v51 offset:16384
    ds_read_b64_tr_b16 v[144:145], v48 offset:32768
    ds_read_b64_tr_b16 v[146:147], v50 offset:32768
    ds_read_b64_tr_b16 v[148:149], v49 offset:32768
    ds_read_b64_tr_b16 v[150:151], v51 offset:32768
    ds_read_b64_tr_b16 v[152:153], v48 offset:49152
    ds_read_b64_tr_b16 v[154:155], v50 offset:49152
    ds_read_b64_tr_b16 v[156:157], v49 offset:49152
    ds_read_b64_tr_b16 v[158:159], v51 offset:49152
    ds_read_b64_tr_b16 v[160:161], v52 offset:0
    ds_read_b64_tr_b16 v[162:163], v54 offset:0
    ds_read_b64_tr_b16 v[164:165], v53 offset:0
    ds_read_b64_tr_b16 v[166:167], v55 offset:0
    ds_read_b64_tr_b16 v[168:169], v52 offset:16384
    ds_read_b64_tr_b16 v[170:171], v54 offset:16384
    ds_read_b64_tr_b16 v[172:173], v53 offset:16384
    ds_read_b64_tr_b16 v[174:175], v55 offset:16384
    ds_read_b64_tr_b16 v[176:177], v52 offset:32768
    ds_read_b64_tr_b16 v[178:179], v54 offset:32768
    ds_read_b64_tr_b16 v[180:181], v53 offset:32768
    ds_read_b64_tr_b16 v[182:183], v55 offset:32768
    ds_read_b64_tr_b16 v[184:185], v52 offset:49152
    ds_read_b64_tr_b16 v[186:187], v54 offset:49152
    ds_read_b64_tr_b16 v[188:189], v53 offset:49152
    ds_read_b64_tr_b16 v[190:191], v55 offset:49152
    v_and_b32 v6, 15, v8
    v_xor_b32 v6, v6, v9
    v_lshlrev_b32 v6, 4, v6
    v_lshl_add_u32 v6, v8, 10, v6
    s_add_u32 s95, s95, 131072
    v_add_u32 v56, s95, v6
    v_xor_b32 v57, 32, v56
    v_xor_b32 v58, 64, v56
    v_xor_b32 v59, 96, v56
    v_xor_b32 v60, 128, v56
    v_xor_b32 v61, 160, v56
    v_xor_b32 v62, 192, v56
    v_xor_b32 v63, 224, v56
    s_and_b32 s92, s3, 3
    s_lshl_b32 s92, s92, 2
    s_add_u32 s92, s92, 0
    s_lshl_b32 s92, s92, 4
    v_lshlrev_b32 v5, 4, v1
    v_xor_b32 v5, s92, v5
    s_lshl_b32 s93, s3, 12
    s_add_u32 s93, s93, 131072
    v_add_u32 v48, s93, v5
    s_and_b32 s92, s3, 3
    s_lshl_b32 s92, s92, 2
    s_add_u32 s92, s92, 1
    s_lshl_b32 s92, s92, 4
    v_lshlrev_b32 v5, 4, v1
    v_xor_b32 v5, s92, v5
    s_lshl_b32 s93, s3, 12
    s_add_u32 s93, s93, 132096
    v_add_u32 v49, s93, v5
    s_and_b32 s92, s3, 3
    s_lshl_b32 s92, s92, 2
    s_add_u32 s92, s92, 2
    s_lshl_b32 s92, s92, 4
    v_lshlrev_b32 v5, 4, v1
    v_xor_b32 v5, s92, v5
    s_lshl_b32 s93, s3, 12
    s_add_u32 s93, s93, 133120
    v_add_u32 v50, s93, v5
    s_and_b32 s92, s3, 3
    s_lshl_b32 s92, s92, 2
    s_add_u32 s92, s92, 3
    s_lshl_b32 s92, s92, 4
    v_lshlrev_b32 v5, 4, v1
    v_xor_b32 v5, s92, v5
    s_lshl_b32 s93, s3, 12
    s_add_u32 s93, s93, 134144
    v_add_u32 v51, s93, v5
    s_mov_b32 s5, 0
    s_waitcnt vmcnt(0)
RC_28:
    v_bitop3_b32 v10, v16, v17, v18 bitop3:0x96
    v_bitop3_b32 v11, v20, v21, v22 bitop3:0x96
    v_bitop3_b32 v12, v24, v25, v26 bitop3:0x96
    v_bitop3_b32 v13, v28, v29, v30 bitop3:0x96
    v_xor_b32 v10, v10, v19
    v_xor_b32 v11, v11, v23
    v_xor_b32 v12, v12, v27
    v_xor_b32 v13, v13, v31
    v_xor_b32_dpp v10, v10, v10 row_ror:8 row_mask:0xf bank_mask:0xf
    v_xor_b32_dpp v11, v11, v11 row_ror:8 row_mask:0xf bank_mask:0xf
    v_xor_b32_dpp v12, v12, v12 row_ror:8 row_mask:0xf bank_mask:0xf
    v_xor_b32_dpp v13, v13, v13 row_ror:8 row_mask:0xf bank_mask:0xf
    v_xor_b32_dpp v10, v10, v10 row_ror:4 row_mask:0xf bank_mask:0xf
    v_xor_b32_dpp v11, v11, v11 row_ror:4 row_mask:0xf bank_mask:0xf
    v_xor_b32_dpp v12, v12, v12 row_ror:4 row_mask:0xf bank_mask:0xf
    v_xor_b32_dpp v13, v13, v13 row_ror:4 row_mask:0xf bank_mask:0xf
    v_xor_b32_dpp v10, v10, v10 row_ror:2 row_mask:0xf bank_mask:0xf
    v_xor_b32_dpp v11, v11, v11 row_ror:2 row_mask:0xf bank_mask:0xf
    v_xor_b32_dpp v12, v12, v12 row_ror:2 row_mask:0xf bank_mask:0xf
    v_xor_b32_dpp v13, v13, v13 row_ror:2 row_mask:0xf bank_mask:0xf
    v_xor_b32_dpp v10, v10, v10 row_ror:1 row_mask:0xf bank_mask:0xf
    v_xor_b32_dpp v11, v11, v11 row_ror:1 row_mask:0xf bank_mask:0xf
    v_xor_b32_dpp v12, v12, v12 row_ror:1 row_mask:0xf bank_mask:0xf
    v_xor_b32_dpp v13, v13, v13 row_ror:1 row_mask:0xf bank_mask:0xf
    v_cndmask_b32 v10, v10, v11, s[0:1]
    v_cndmask_b32 v12, v12, v13, s[0:1]
    v_cndmask_b32 v14, v10, v12, s[90:91]
    v_cmp_eq_u32 vcc, v14, v32
    v_cmp_eq_u32 s[16:17], s8, v33
    s_nop 0
    s_and_b64 vcc, vcc, s[16:17]
    s_cmp_eq_u64 vcc, exec
    s_cbranch_scc1 RD_29
    s_add_u32 s5, s5, 1
    s_cmp_ge_u32 s5, 300000
    s_cbranch_scc1 RD_29
    v_lshlrev_b32 v5, 4, v1
    buffer_load_dwordx4 v[16:19], v5, s[80:83], s96 offen offset:0 sc0 sc1
    buffer_load_dwordx4 v[20:23], v5, s[80:83], s96 offen offset:1024 sc0 sc1
    buffer_load_dwordx4 v[24:27], v5, s[80:83], s96 offen offset:2048 sc0 sc1
    buffer_load_dwordx4 v[28:31], v5, s[80:83], s96 offen offset:3072 sc0 sc1
    v_and_b32 v6, 3, v3
    v_lshlrev_b32 v6, 5, v6
    v_lshl_add_u32 v6, v2, 3, v6
    buffer_load_dwordx2 v[32:33], v6, s[80:83], s97 offen sc0 sc1
    s_waitcnt vmcnt(0)
    s_branch RC_28
RD_29:
    ds_write_b128 v48, v[16:19]
    ds_write_b128 v49, v[20:23]
    ds_write_b128 v50, v[24:27]
    ds_write_b128 v51, v[28:31]
    s_waitcnt lgkmcnt(0)
    s_barrier
    ds_read_b128 v[224:227], v56 offset:0
    ds_read_b128 v[228:231], v57 offset:0
    ds_read_b128 v[232:235], v58 offset:0
    ds_read_b128 v[236:239], v59 offset:0
    ds_read_b128 v[240:243], v60 offset:0
    ds_read_b128 v[244:247], v61 offset:0
    ds_read_b128 v[248:251], v62 offset:0
    ds_read_b128 v[252:255], v63 offset:0
    v_lshrrev_b32 v5, 4, v1
    v_lshlrev_b32 v6, 1, v5
    v_xor_b32 v6, v6, v3
    v_lshlrev_b32 v6, 4, v6
    v_lshl_add_u32 v5, v5, 13, v6
    v_xor_b32 v6, 128, v5
    s_lshl_b32 s92, s7, 7
    s_lshl_b32 s93, s3, 4
    s_add_u32 s92, s92, s93
    s_lshl_b32 s92, s92, 13
    s_lshl_b32 s93, s6, 8
    s_add_u32 s92, s92, s93
    s_lshl_b32 s93, s3, 12
    s_add_u32 m0, s93, 32768
    s_nop 0
    buffer_load_dwordx4 v5, s[56:59], s92 offen nt lds
    s_add_u32 s92, s92, 32768
    s_add_u32 m0, s93, 33792
    s_nop 0
    buffer_load_dwordx4 v6, s[56:59], s92 offen nt lds
    s_add_u32 s92, s92, 32768
    s_add_u32 m0, s93, 34816
    s_nop 0
    buffer_load_dwordx4 v5, s[56:59], s92 offen nt lds
    s_add_u32 s92, s92, 32768
    s_add_u32 m0, s93, 35840
    s_nop 0
    buffer_load_dwordx4 v6, s[56:59], s92 offen nt lds
    s_waitcnt lgkmcnt(7)
    v_mfma_f32_32x32x16_bf16 v[32:47], v[64:67], v[224:227], 0
    ds_read_b128 v[224:227], v56 offset:256
    s_waitcnt lgkmcnt(7)
    v_mfma_f32_32x32x16_bf16 v[32:47], v[68:71], v[228:231], v[32:47]
    ds_read_b128 v[228:231], v57 offset:256
    s_waitcnt lgkmcnt(7)
    v_mfma_f32_32x32x16_bf16 v[32:47], v[72:75], v[232:235], v[32:47]
    ds_read_b128 v[232:235], v58 offset:256
    s_waitcnt lgkmcnt(7)
    v_mfma_f32_32x32x16_bf16 v[32:47], v[76:79], v[236:239], v[32:47]
    ds_read_b128 v[236:239], v59 offset:256
    s_waitcnt lgkmcnt(7)
    v_mfma_f32_32x32x16_bf16 v[32:47], v[80:83], v[240:243], v[32:47]
    ds_read_b128 v[240:243], v60 offset:256
    s_waitcnt lgkmcnt(7)
    v_mfma_f32_32x32x16_bf16 v[32:47], v[84:87], v[244:247], v[32:47]
    ds_read_b128 v[244:247], v61 offset:256
    s_waitcnt lgkmcnt(7)
    v_mfma_f32_32x32x16_bf16 v[32:47], v[88:91], v[248:251], v[32:47]
    ds_read_b128 v[248:251], v62 offset:256
    s_waitcnt lgkmcnt(7)
    v_mfma_f32_32x32x16_bf16 v[32:47], v[92:95], v[252:255], v[32:47]
    ds_read_b128 v[252:255], v63 offset:256
    s_waitcnt lgkmcnt(7)
    v_mfma_f32_32x32x16_bf16 v[32:47], v[96:99], v[224:227], v[32:47]
    s_waitcnt lgkmcnt(6)
    v_mfma_f32_32x32x16_bf16 v[32:47], v[100:103], v[228:231], v[32:47]
    s_waitcnt lgkmcnt(5)
    v_mfma_f32_32x32x16_bf16 v[32:47], v[104:107], v[232:235], v[32:47]
    s_waitcnt lgkmcnt(4)
    v_mfma_f32_32x32x16_bf16 v[32:47], v[108:111], v[236:239], v[32:47]
    s_waitcnt lgkmcnt(3)
    v_mfma_f32_32x32x16_bf16 v[32:47], v[112:115], v[240:243], v[32:47]
    s_waitcnt lgkmcnt(2)
    v_mfma_f32_32x32x16_bf16 v[32:47], v[116:119], v[244:247], v[32:47]
    s_waitcnt lgkmcnt(1)
    v_mfma_f32_32x32x16_bf16 v[32:47], v[120:123], v[248:251], v[32:47]
    s_waitcnt lgkmcnt(0)
    v_mfma_f32_32x32x16_bf16 v[32:47], v[124:127], v[252:255], v[32:47]
    s_lshl_b32 s94, s3, 11
    s_add_u32 s94, s94, 131072
    v_lshlrev_b32 v7, 4, v1
    v_add_u32 v5, s94, v7
    s_xor_b32 s95, s3, 4
    s_lshl_b32 s95, s95, 11
    s_add_u32 s95, s95, 131072
    v_add_u32 v6, s95, v7
    s_lshl_b32 s94, s3, 7
    v_lshlrev_b32 v13, 2, v8
    v_add_u32 v14, 147456, v13
    v_add_u32 v15, s94, v14
    s_lshl_b32 s95, s98, 1
    s_add_u32 s95, s95, s99
    s_lshl_b32 s95, s95, 10
    s_add_u32 s95, s95, 149504
    v_add_u32 v56, s95, v7
    v_add_u32 v57, 149504, v7
    v_add_u32 v58, 1024, v15
    v_add_u32 v59, 1024, v14
    s_barrier
    s_cmp_eq_u32 s99, 0
    s_cbranch_scc0 CH_30
    ds_write_b128 v5, v[40:43]
    ds_write_b128 v5, v[44:47] offset:1024
    s_branch CH_31
CH_30:
    ds_write_b128 v5, v[32:35]
    ds_write_b128 v5, v[36:39] offset:1024
    v_mov_b32 v32, v40
    v_mov_b32 v33, v41
    v_mov_b32 v34, v42
    v_mov_b32 v35, v43
    v_mov_b32 v36, v44
    v_mov_b32 v37, v45
    v_mov_b32 v38, v46
    v_mov_b32 v39, v47
CH_31:
    s_waitcnt lgkmcnt(0)
    s_barrier
    ds_read_b128 v[48:51], v6
    ds_read_b128 v[52:55], v6 offset:1024
    s_waitcnt lgkmcnt(0)
    v_add_f32 v48, v48, v32
    v_add_f32 v49, v49, v33
    v_add_f32 v50, v50, v34
    v_add_f32 v51, v51, v35
    v_add_f32 v52, v52, v36
    v_add_f32 v53, v53, v37
    v_add_f32 v54, v54, v38
    v_add_f32 v55, v55, v39
    v_max3_f32 v10, v48, v49, v50
    v_max3_f32 v10, v10, v51, v52
    v_max3_f32 v10, v10, v53, v54
    v_max_f32 v10, v10, v55
    v_mov_b32 v12, v10
    s_nop 1
    v_permlane32_swap_b32 v10, v12
    v_max_f32 v10, v10, v12
    ds_write_b32 v15, v10
    s_waitcnt lgkmcnt(0)
    s_barrier
    ds_read_b32 v32, v14 offset:0
    ds_read_b32 v33, v14 offset:128
    ds_read_b32 v34, v14 offset:256
    ds_read_b32 v35, v14 offset:384
    ds_read_b32 v36, v14 offset:512
    ds_read_b32 v37, v14 offset:640
    ds_read_b32 v38, v14 offset:768
    ds_read_b32 v39, v14 offset:896
    s_waitcnt lgkmcnt(0)
    v_max3_f32 v10, v32, v33, v34
    v_max3_f32 v10, v10, v35, v36
    v_max3_f32 v10, v10, v37, v38
    v_max_f32 v10, v10, v39
    v_mul_f32 v10, s14, v10
    v_fma_f32 v48, v48, s14, -v10
    v_fma_f32 v49, v49, s14, -v10
    v_fma_f32 v50, v50, s14, -v10
    v_fma_f32 v51, v51, s14, -v10
    v_fma_f32 v52, v52, s14, -v10
    v_fma_f32 v53, v53, s14, -v10
    v_fma_f32 v54, v54, s14, -v10
    v_fma_f32 v55, v55, s14, -v10
    v_exp_f32 v48, v48
    v_exp_f32 v49, v49
    v_exp_f32 v50, v50
    v_exp_f32 v51, v51
    v_exp_f32 v52, v52
    v_exp_f32 v53, v53
    v_exp_f32 v54, v54
    v_exp_f32 v55, v55
    v_cvt_pk_bf16_f32 v40, v48, v49
    v_cvt_pk_bf16_f32 v41, v50, v51
    v_cvt_pk_bf16_f32 v42, v52, v53
    v_cvt_pk_bf16_f32 v43, v54, v55
    ds_write_b128 v56, v[40:43]
    v_add_f32 v48, v48, v49
    v_add_f32 v50, v50, v51
    v_add_f32 v52, v52, v53
    v_add_f32 v54, v54, v55
    v_add_f32 v48, v48, v50
    v_add_f32 v52, v52, v54
    v_add_f32 v11, v48, v52
    v_mov_b32 v12, v11
    s_nop 1
    v_permlane32_swap_b32 v11, v12
    v_add_f32 v11, v11, v12
    ds_write_b32 v58, v11
    s_waitcnt lgkmcnt(0)
    s_barrier
    ds_read_b128 v[64:67], v57 offset:0
    ds_read_b128 v[68:71], v57 offset:1024
    ds_read_b128 v[72:75], v57 offset:2048
    ds_read_b128 v[76:79], v57 offset:3072
    ds_read_b128 v[80:83], v57 offset:4096
    ds_read_b128 v[84:87], v57 offset:5120
    ds_read_b128 v[88:91], v57 offset:6144
    ds_read_b128 v[92:95], v57 offset:7168
    ds_read_b32 v32, v59 offset:0
    ds_read_b32 v33, v59 offset:128
    ds_read_b32 v34, v59 offset:256
    ds_read_b32 v35, v59 offset:384
    ds_read_b32 v36, v59 offset:512
    ds_read_b32 v37, v59 offset:640
    ds_read_b32 v38, v59 offset:768
    ds_read_b32 v39, v59 offset:896
    s_waitcnt lgkmcnt(15)
    v_mfma_f32_32x32x16_bf16 v[96:111], v[128:131], v[64:67], 0
    v_mfma_f32_32x32x16_bf16 v[112:127], v[132:135], v[64:67], 0
    s_waitcnt lgkmcnt(14)
    v_mfma_f32_32x32x16_bf16 v[96:111], v[136:139], v[68:71], v[96:111]
    v_mfma_f32_32x32x16_bf16 v[112:127], v[140:143], v[68:71], v[112:127]
    s_waitcnt lgkmcnt(13)
    v_mfma_f32_32x32x16_bf16 v[96:111], v[144:147], v[72:75], v[96:111]
    v_mfma_f32_32x32x16_bf16 v[112:127], v[148:151], v[72:75], v[112:127]
    s_waitcnt lgkmcnt(12)
    v_mfma_f32_32x32x16_bf16 v[96:111], v[152:155], v[76:79], v[96:111]
    v_mfma_f32_32x32x16_bf16 v[112:127], v[156:159], v[76:79], v[112:127]
    s_waitcnt lgkmcnt(11)
    v_mfma_f32_32x32x16_bf16 v[96:111], v[160:163], v[80:83], v[96:111]
    v_mfma_f32_32x32x16_bf16 v[112:127], v[164:167], v[80:83], v[112:127]
    s_waitcnt lgkmcnt(10)
    v_mfma_f32_32x32x16_bf16 v[96:111], v[168:171], v[84:87], v[96:111]
    v_mfma_f32_32x32x16_bf16 v[112:127], v[172:175], v[84:87], v[112:127]
    s_waitcnt lgkmcnt(9)
    v_mfma_f32_32x32x16_bf16 v[96:111], v[176:179], v[88:91], v[96:111]
    v_mfma_f32_32x32x16_bf16 v[112:127], v[180:183], v[88:91], v[112:127]
    s_waitcnt lgkmcnt(8)
    v_mfma_f32_32x32x16_bf16 v[96:111], v[184:187], v[92:95], v[96:111]
    v_mfma_f32_32x32x16_bf16 v[112:127], v[188:191], v[92:95], v[112:127]
    v_and_b32 v5, 15, v8
    s_and_b32 s94, s3, 1
    s_lshl_b32 s94, s94, 3
    v_xor_b32 v5, s94, v5
    v_lshlrev_b32 v5, 4, v5
    v_lshl_add_u32 v5, v9, 3, v5
    v_lshl_add_u32 v5, v8, 10, v5
    s_lshr_b32 s94, s3, 1
    s_lshl_b32 s94, s94, 8
    v_add_u32 v48, s94, v5
    v_xor_b32 v49, 16, v48
    v_xor_b32 v50, 32, v48
    v_xor_b32 v51, 48, v48
    v_xor_b32 v52, 64, v48
    v_xor_b32 v53, 80, v48
    v_xor_b32 v54, 96, v48
    v_xor_b32 v55, 112, v48
    s_and_b32 s94, s3, 3
    s_lshl_b32 s94, s94, 2
    s_add_u32 s94, s94, 0
    s_lshl_b32 s94, s94, 4
    v_lshlrev_b32 v5, 4, v1
    v_xor_b32 v5, s94, v5
    s_lshl_b32 s95, s3, 12
    s_add_u32 s95, s95, 0
    v_add_u32 v56, s95, v5
    s_and_b32 s94, s3, 3
    s_lshl_b32 s94, s94, 2
    s_add_u32 s94, s94, 1
    s_lshl_b32 s94, s94, 4
    v_lshlrev_b32 v5, 4, v1
    v_xor_b32 v5, s94, v5
    s_lshl_b32 s95, s3, 12
    s_add_u32 s95, s95, 1024
    v_add_u32 v57, s95, v5
    s_and_b32 s94, s3, 3
    s_lshl_b32 s94, s94, 2
    s_add_u32 s94, s94, 2
    s_lshl_b32 s94, s94, 4
    v_lshlrev_b32 v5, 4, v1
    v_xor_b32 v5, s94, v5
    s_lshl_b32 s95, s3, 12
    s_add_u32 s95, s95, 2048
    v_add_u32 v58, s95, v5
    s_and_b32 s94, s3, 3
    s_lshl_b32 s94, s94, 2
    s_add_u32 s94, s94, 3
    s_lshl_b32 s94, s94, 4
    v_lshlrev_b32 v5, 4, v1
    v_xor_b32 v5, s94, v5
    s_lshl_b32 s95, s3, 12
    s_add_u32 s95, s95, 3072
    v_add_u32 v59, s95, v5
    s_waitcnt lgkmcnt(0)
    v_add_f32 v32, v32, v33
    v_add_f32 v34, v34, v35
    v_add_f32 v36, v36, v37
    v_add_f32 v38, v38, v39
    v_add_f32 v32, v32, v34
    v_add_f32 v36, v36, v38
    v_add_f32 v11, v32, v36
    v_lshlrev_b32 v6, 3, v8
    v_add_u32 v6, 147456, v6
    ds_write_b64 v6, v[10:11]
    v_and_b32 v6, 3, v3
    s_lshl_b32 s94, s3, 5
    s_add_u32 s94, s94, 147456
    v_lshlrev_b32 v7, 3, v6
    v_add_u32 v7, s94, v7
    v_lshlrev_b32 v6, 6, v6
    v_lshl_add_u32 v6, v2, 4, v6
    s_lshl_b32 s94, s3, 8
    s_lshl_b32 s95, s4, 11
    s_add_u32 s94, s94, s95
    s_add_u32 s94, s94, 1835008
    s_lshl_b32 s95, s4, 15
    s_lshl_b32 s96, s3, 12
    s_add_u32 s95, s95, s96
    s_add_u32 s95, s95, 2097152
    v_lshlrev_b32 v5, 4, v1
    v_cvt_pk_bf16_f32 v96, v96, v97
    v_cvt_pk_bf16_f32 v97, v98, v99
    ds_write_b64 v48, v[96:97]
    v_cvt_pk_bf16_f32 v100, v100, v101
    v_cvt_pk_bf16_f32 v101, v102, v103
    ds_write_b64 v49, v[100:101]
    v_cvt_pk_bf16_f32 v104, v104, v105
    v_cvt_pk_bf16_f32 v105, v106, v107
    ds_write_b64 v50, v[104:105]
    v_cvt_pk_bf16_f32 v108, v108, v109
    v_cvt_pk_bf16_f32 v109, v110, v111
    ds_write_b64 v51, v[108:109]
    v_cvt_pk_bf16_f32 v112, v112, v113
    v_cvt_pk_bf16_f32 v113, v114, v115
    ds_write_b64 v52, v[112:113]
    v_cvt_pk_bf16_f32 v116, v116, v117
    v_cvt_pk_bf16_f32 v117, v118, v119
    ds_write_b64 v53, v[116:117]
    v_cvt_pk_bf16_f32 v120, v120, v121
    v_cvt_pk_bf16_f32 v121, v122, v123
    ds_write_b64 v54, v[120:121]
    v_cvt_pk_bf16_f32 v124, v124, v125
    v_cvt_pk_bf16_f32 v125, v126, v127
    ds_write_b64 v55, v[124:125]
    s_waitcnt vmcnt(0)
    s_waitcnt lgkmcnt(0)
    s_barrier
    ds_read_b128 v[32:35], v56
    ds_read_b128 v[36:39], v57
    ds_read_b128 v[40:43], v58
    ds_read_b128 v[44:47], v59
    ds_read_b64 v[48:49], v7
    v_mov_b32 v51, s8
    s_waitcnt lgkmcnt(0)
    buffer_store_dwordx4 v[32:35], v5, s[80:83], s95 offen offset:0 sc0 sc1
    buffer_store_dwordx4 v[36:39], v5, s[80:83], s95 offen offset:1024 sc0 sc1
    buffer_store_dwordx4 v[40:43], v5, s[80:83], s95 offen offset:2048 sc0 sc1
    buffer_store_dwordx4 v[44:47], v5, s[80:83], s95 offen offset:3072 sc0 sc1
    v_bitop3_b32 v10, v32, v33, v34 bitop3:0x96
    v_bitop3_b32 v11, v36, v37, v38 bitop3:0x96
    v_bitop3_b32 v12, v40, v41, v42 bitop3:0x96
    v_bitop3_b32 v13, v44, v45, v46 bitop3:0x96
    v_xor_b32 v10, v10, v35
    v_xor_b32 v11, v11, v39
    v_xor_b32 v12, v12, v43
    v_xor_b32 v13, v13, v47
    v_xor_b32_dpp v10, v10, v10 row_ror:8 row_mask:0xf bank_mask:0xf
    v_xor_b32_dpp v11, v11, v11 row_ror:8 row_mask:0xf bank_mask:0xf
    v_xor_b32_dpp v12, v12, v12 row_ror:8 row_mask:0xf bank_mask:0xf
    v_xor_b32_dpp v13, v13, v13 row_ror:8 row_mask:0xf bank_mask:0xf
    v_xor_b32_dpp v10, v10, v10 row_ror:4 row_mask:0xf bank_mask:0xf
    v_xor_b32_dpp v11, v11, v11 row_ror:4 row_mask:0xf bank_mask:0xf
    v_xor_b32_dpp v12, v12, v12 row_ror:4 row_mask:0xf bank_mask:0xf
    v_xor_b32_dpp v13, v13, v13 row_ror:4 row_mask:0xf bank_mask:0xf
    v_xor_b32_dpp v10, v10, v10 row_ror:2 row_mask:0xf bank_mask:0xf
    v_xor_b32_dpp v11, v11, v11 row_ror:2 row_mask:0xf bank_mask:0xf
    v_xor_b32_dpp v12, v12, v12 row_ror:2 row_mask:0xf bank_mask:0xf
    v_xor_b32_dpp v13, v13, v13 row_ror:2 row_mask:0xf bank_mask:0xf
    v_xor_b32_dpp v10, v10, v10 row_ror:1 row_mask:0xf bank_mask:0xf
    v_xor_b32_dpp v11, v11, v11 row_ror:1 row_mask:0xf bank_mask:0xf
    v_xor_b32_dpp v12, v12, v12 row_ror:1 row_mask:0xf bank_mask:0xf
    v_xor_b32_dpp v13, v13, v13 row_ror:1 row_mask:0xf bank_mask:0xf
    v_cndmask_b32 v10, v10, v11, s[0:1]
    v_cndmask_b32 v12, v12, v13, s[0:1]
    v_cndmask_b32 v50, v10, v12, s[90:91]
    s_mov_b32 exec_lo, 0x000f000f
    s_mov_b32 exec_hi, 0x000f000f
    buffer_store_dwordx4 v[48:51], v6, s[80:83], s94 offen sc0 sc1
    s_mov_b64 exec, -1
    v_add_u32 v192, 0, v1
    v_mul_u32_u24 v5, 3641, v192
    v_lshrrev_b32 v5, 16, v5
    v_lshlrev_b32 v192, 4, v192
    v_mul_u32_u24 v5, 864, v5
    v_add_u32 v192, v192, v5
    v_add_u32 v193, 64, v1
    v_mul_u32_u24 v5, 3641, v193
    v_lshrrev_b32 v5, 16, v5
    v_lshlrev_b32 v193, 4, v193
    v_mul_u32_u24 v5, 864, v5
    v_add_u32 v193, v193, v5
    v_add_u32 v194, 128, v1
    v_mul_u32_u24 v5, 3641, v194
    v_lshrrev_b32 v5, 16, v5
    v_lshlrev_b32 v194, 4, v194
    v_mul_u32_u24 v5, 864, v5
    v_add_u32 v194, v194, v5
    v_add_u32 v195, 192, v1
    v_mul_u32_u24 v5, 3641, v195
    v_lshrrev_b32 v5, 16, v5
    v_lshlrev_b32 v195, 4, v195
    v_mul_u32_u24 v5, 864, v5
    v_add_u32 v195, v195, v5
    v_add_u32 v196, 256, v1
    v_mul_u32_u24 v5, 3641, v196
    v_lshrrev_b32 v5, 16, v5
    v_lshlrev_b32 v196, 4, v196
    v_mul_u32_u24 v5, 864, v5
    v_add_u32 v196, v196, v5
    s_lshl_b32 s96, s3, 19
    s_lshl_b32 s94, s4, 8
    s_add_u32 s96, s96, s94
    s_add_u32 s96, s96, 2097152
    s_lshl_b32 s97, s3, 15
    s_lshl_b32 s94, s4, 4
    s_add_u32 s97, s97, s94
    s_add_u32 s97, s97, 1835008
    v_and_b32 v6, 3, v3
    v_lshl_add_u32 v6, v2, 2, v6
    v_lshlrev_b32 v14, 2, v6
    s_and_b32 s94, s3, 3
    s_lshl_b32 s94, s94, 4
    s_lshl_b32 s94, s94, 2
    v_lshlrev_b32 v15, 4, v2
    v_add_u32 v15, s94, v15
    v_add_u32 v13, 8, v15
    v_lshlrev_b32 v7, 17, v2
    v_lshl_add_u32 v7, v3, 4, v7
    v_lshrrev_b32 v5, 2, v3
    v_bfe_u32 v6, v3, 1, 1
    s_lshl_b32 s94, s3, 1
    v_or_b32 v6, s94, v6
    v_lshlrev_b32 v8, 1, v5
    v_xor_b32 v6, v6, v8
    v_lshlrev_b32 v6, 4, v6
    v_lshl_add_u32 v5, v2, 3, v5
    v_lshl_add_u32 v6, v5, 8, v6
    v_and_b32 v5, 1, v3
    v_lshl_add_u32 v5, v5, 3, v6
    v_add_u32 v5, 32768, v5
    v_xor_b32 v6, 128, v5
    ds_read_b64_tr_b16 v[164:165], v5 offset:0
    ds_read_b64_tr_b16 v[166:167], v6 offset:1024
    ds_read_b64_tr_b16 v[168:169], v5 offset:8192
    ds_read_b64_tr_b16 v[170:171], v6 offset:9216
    ds_read_b64_tr_b16 v[172:173], v5 offset:16384
    ds_read_b64_tr_b16 v[174:175], v6 offset:17408
    ds_read_b64_tr_b16 v[176:177], v5 offset:24576
    ds_read_b64_tr_b16 v[178:179], v6 offset:25600
    s_lshl_b32 s98, s3, 7
    s_add_u32 s98, s98, 139264
    v_lshl_add_u32 v10, v1, 3, s98
    s_lshr_b32 s98, s3, 2
    s_lshl_b32 s98, s98, 9
    s_add_u32 s98, s98, 139264
    v_lshl_add_u32 v11, v1, 3, s98
    v_lshlrev_b32 v9, 11, v1
    s_waitcnt vmcnt(0)
    s_mov_b32 exec_lo, 0x0000ffff
    s_mov_b32 exec_hi, 0x00000000
    buffer_load_dwordx4 v[80:83], v9, s[80:83], s97 offen sc0 sc1
    s_mov_b64 exec, -1
    s_add_u32 s94, s96, 0
    buffer_load_dwordx4 v[64:67], v7, s[80:83], s94 offen sc0 sc1
    s_add_u32 s94, s96, 32768
    buffer_load_dwordx4 v[68:71], v7, s[80:83], s94 offen sc0 sc1
    s_add_u32 s94, s96, 65536
    buffer_load_dwordx4 v[72:75], v7, s[80:83], s94 offen sc0 sc1
    s_add_u32 s94, s96, 98304
    buffer_load_dwordx4 v[76:79], v7, s[80:83], s94 offen sc0 sc1
    s_mov_b32 exec_lo, 0x0000ffff
    s_mov_b32 exec_hi, 0x00000000
    s_mov_b32 s5, 0
    s_waitcnt vmcnt(4)
RC_32:
    v_cmp_eq_u32 vcc, s8, v83
    s_nop 0
    s_cmp_eq_u64 vcc, exec
    s_cbranch_scc1 RD_33
    s_add_u32 s5, s5, 1
    s_cmp_ge_u32 s5, 300000
    s_cbranch_scc1 RD_33
    s_sleep 4
    buffer_load_dwordx4 v[80:83], v9, s[80:83], s97 offen sc0 sc1
    s_mov_b64 exec, -1
    s_add_u32 s94, s96, 0
    buffer_load_dwordx4 v[64:67], v7, s[80:83], s94 offen sc0 sc1
    s_add_u32 s94, s96, 32768
    buffer_load_dwordx4 v[68:71], v7, s[80:83], s94 offen sc0 sc1
    s_add_u32 s94, s96, 65536
    buffer_load_dwordx4 v[72:75], v7, s[80:83], s94 offen sc0 sc1
    s_add_u32 s94, s96, 98304
    buffer_load_dwordx4 v[76:79], v7, s[80:83], s94 offen sc0 sc1
    s_mov_b32 exec_lo, 0x0000ffff
    s_mov_b32 exec_hi, 0x00000000
    s_waitcnt vmcnt(4)
    s_branch RC_32
RD_33:
    ds_write_b64 v10, v[80:81]
    s_mov_b64 exec, -1
    s_waitcnt lgkmcnt(0)
    s_barrier
    ds_read_b64 v[80:81], v11
    ds_bpermute_b32 v12, v14, v82
    s_add_u32 s92, s6, 4
    s_and_b32 s92, s92, 31
    s_lshl_b32 s92, s92, 7
    s_lshl_b32 s93, s3, 4
    s_add_u32 s92, s92, s93
    s_mul_i32 s92, s92, 1152
    s_mul_i32 s93, s7, 288
    s_add_u32 s92, s92, s93
    s_mul_i32 s93, s3, 4608
    s_add_u32 m0, s93, 65536
    s_nop 0
    buffer_load_dwordx4 v192, s[60:63], s92 offen nt lds
    s_add_u32 m0, s93, 66560
    s_nop 0
    buffer_load_dwordx4 v193, s[60:63], s92 offen nt lds
    s_add_u32 m0, s93, 67584
    s_nop 0
    buffer_load_dwordx4 v194, s[60:63], s92 offen nt lds
    s_mov_b64 exec, -1
    s_waitcnt lgkmcnt(0)
    v_mov_b32 v8, v80
    s_nop 1
    v_max_f32_dpp v8, v8, v8 row_ror:8 row_mask:0xf bank_mask:0xf
    s_nop 1
    v_max_f32_dpp v8, v8, v8 row_ror:4 row_mask:0xf bank_mask:0xf
    s_nop 1
    v_max_f32_dpp v8, v8, v8 row_ror:2 row_mask:0xf bank_mask:0xf
    s_nop 1
    v_max_f32_dpp v8, v8, v8 row_ror:1 row_mask:0xf bank_mask:0xf
    v_mov_b32 v9, v8
    s_nop 1
    v_permlane16_swap_b32 v8, v9
    v_max_f32 v8, v8, v9
    v_mov_b32 v9, v8
    s_nop 1
    v_permlane32_swap_b32 v8, v9
    v_max_f32 v8, v8, v9
    v_sub_f32 v8, v80, v8
    v_exp_f32 v8, v8
    s_nop 0
    v_mul_f32 v10, v8, v81
    s_waitcnt vmcnt(3)
    s_nop 0
    v_add_f32_dpp v10, v10, v10 row_ror:8 row_mask:0xf bank_mask:0xf
    v_bitop3_b32 v32, v64, v65, v66 bitop3:0x96
    v_bitop3_b32 v33, v68, v69, v70 bitop3:0x96
    v_add_f32_dpp v10, v10, v10 row_ror:4 row_mask:0xf bank_mask:0xf
    v_bitop3_b32 v34, v72, v73, v74 bitop3:0x96
    v_bitop3_b32 v35, v76, v77, v78 bitop3:0x96
    v_add_f32_dpp v10, v10, v10 row_ror:2 row_mask:0xf bank_mask:0xf
    v_xor_b32 v32, v32, v67
    v_xor_b32 v33, v33, v71
    v_add_f32_dpp v10, v10, v10 row_ror:1 row_mask:0xf bank_mask:0xf
    v_xor_b32 v34, v34, v75
    v_xor_b32 v35, v35, v79
    v_mov_b32 v9, v10
    v_xor_b32_dpp v32, v32, v32 row_ror:8 row_mask:0xf bank_mask:0xf
    v_xor_b32_dpp v33, v33, v33 row_ror:8 row_mask:0xf bank_mask:0xf
    v_permlane16_swap_b32 v10, v9
    v_xor_b32_dpp v34, v34, v34 row_ror:8 row_mask:0xf bank_mask:0xf
    v_xor_b32_dpp v35, v35, v35 row_ror:8 row_mask:0xf bank_mask:0xf
    v_add_f32 v10, v10, v9
    v_xor_b32_dpp v32, v32, v32 row_ror:4 row_mask:0xf bank_mask:0xf
    v_xor_b32_dpp v33, v33, v33 row_ror:4 row_mask:0xf bank_mask:0xf
    v_mov_b32 v9, v10
    v_xor_b32_dpp v34, v34, v34 row_ror:4 row_mask:0xf bank_mask:0xf
    v_xor_b32_dpp v35, v35, v35 row_ror:4 row_mask:0xf bank_mask:0xf
    v_permlane32_swap_b32 v10, v9
    v_xor_b32_dpp v32, v32, v32 row_ror:2 row_mask:0xf bank_mask:0xf
    v_xor_b32_dpp v33, v33, v33 row_ror:2 row_mask:0xf bank_mask:0xf
    v_add_f32 v10, v10, v9
    v_xor_b32_dpp v34, v34, v34 row_ror:2 row_mask:0xf bank_mask:0xf
    v_xor_b32_dpp v35, v35, v35 row_ror:2 row_mask:0xf bank_mask:0xf
    v_rcp_f32 v10, v10
    v_xor_b32_dpp v32, v32, v32 row_ror:1 row_mask:0xf bank_mask:0xf
    v_xor_b32_dpp v33, v33, v33 row_ror:1 row_mask:0xf bank_mask:0xf
    v_mul_f32 v8, v8, v10
    v_xor_b32_dpp v34, v34, v34 row_ror:1 row_mask:0xf bank_mask:0xf
    v_xor_b32_dpp v35, v35, v35 row_ror:1 row_mask:0xf bank_mask:0xf
    v_mov_b32_dpp v9, v8 row_shl:1 row_mask:0xf bank_mask:0xf
    v_cndmask_b32 v32, v32, v33, s[0:1]
    v_cndmask_b32 v34, v34, v35, s[0:1]
    v_cvt_pk_bf16_f32 v8, v8, v9
    v_cndmask_b32 v11, v32, v34, s[90:91]
    ds_bpermute_b32 v52, v15, v8
    ds_bpermute_b32 v53, v13, v8
    v_perm_b32 v84, v68, v64, s12
    v_perm_b32 v86, v68, v64, s13
    v_perm_b32 v85, v76, v72, s12
    v_perm_b32 v87, v76, v72, s13
    v_perm_b32 v88, v69, v65, s12
    v_perm_b32 v90, v69, v65, s13
    v_perm_b32 v89, v77, v73, s12
    v_perm_b32 v91, v77, v73, s13
    v_perm_b32 v92, v70, v66, s12
    v_perm_b32 v94, v70, v66, s13
    v_perm_b32 v93, v78, v74, s12
    v_perm_b32 v95, v78, v74, s13
    v_perm_b32 v96, v71, v67, s12
    v_perm_b32 v98, v71, v67, s13
    v_perm_b32 v97, v79, v75, s12
    v_perm_b32 v99, v79, v75, s13
    s_lshl_b32 s94, s3, 9
    s_add_u32 s94, s94, 131072
    v_lshlrev_b32 v5, 5, v3
    v_add_u32 v5, s94, v5
    v_lshlrev_b32 v6, 11, v4
    v_lshl_add_u32 v6, v2, 4, v6
    s_lshl_b32 s94, s3, 6
    s_add_u32 s94, s94, 131072
    v_add_u32 v6, s94, v6
    s_waitcnt lgkmcnt(0)
    v_cmp_eq_u32 vcc, v11, v12
    s_nop 0
    s_cmp_eq_u64 vcc, exec
    s_cbranch_scc1 EK_34
    s_add_u32 s94, s96, 0
    buffer_load_dwordx4 v[64:67], v7, s[80:83], s94 offen sc0 sc1
    s_add_u32 s94, s96, 32768
    buffer_load_dwordx4 v[68:71], v7, s[80:83], s94 offen sc0 sc1
    s_add_u32 s94, s96, 65536
    buffer_load_dwordx4 v[72:75], v7, s[80:83], s94 offen sc0 sc1
    s_add_u32 s94, s96, 98304
    buffer_load_dwordx4 v[76:79], v7, s[80:83], s94 offen sc0 sc1
    s_mov_b32 s5, 0
    s_waitcnt vmcnt(0)
RC_35:
    v_bitop3_b32 v32, v64, v65, v66 bitop3:0x96
    v_bitop3_b32 v33, v68, v69, v70 bitop3:0x96
    v_bitop3_b32 v34, v72, v73, v74 bitop3:0x96
    v_bitop3_b32 v35, v76, v77, v78 bitop3:0x96
    v_xor_b32 v32, v32, v67
    v_xor_b32 v33, v33, v71
    v_xor_b32 v34, v34, v75
    v_xor_b32 v35, v35, v79
    v_xor_b32_dpp v32, v32, v32 row_ror:8 row_mask:0xf bank_mask:0xf
    v_xor_b32_dpp v33, v33, v33 row_ror:8 row_mask:0xf bank_mask:0xf
    v_xor_b32_dpp v34, v34, v34 row_ror:8 row_mask:0xf bank_mask:0xf
    v_xor_b32_dpp v35, v35, v35 row_ror:8 row_mask:0xf bank_mask:0xf
    v_xor_b32_dpp v32, v32, v32 row_ror:4 row_mask:0xf bank_mask:0xf
    v_xor_b32_dpp v33, v33, v33 row_ror:4 row_mask:0xf bank_mask:0xf
    v_xor_b32_dpp v34, v34, v34 row_ror:4 row_mask:0xf bank_mask:0xf
    v_xor_b32_dpp v35, v35, v35 row_ror:4 row_mask:0xf bank_mask:0xf
    v_xor_b32_dpp v32, v32, v32 row_ror:2 row_mask:0xf bank_mask:0xf
    v_xor_b32_dpp v33, v33, v33 row_ror:2 row_mask:0xf bank_mask:0xf
    v_xor_b32_dpp v34, v34, v34 row_ror:2 row_mask:0xf bank_mask:0xf
    v_xor_b32_dpp v35, v35, v35 row_ror:2 row_mask:0xf bank_mask:0xf
    v_xor_b32_dpp v32, v32, v32 row_ror:1 row_mask:0xf bank_mask:0xf
    v_xor_b32_dpp v33, v33, v33 row_ror:1 row_mask:0xf bank_mask:0xf
    v_xor_b32_dpp v34, v34, v34 row_ror:1 row_mask:0xf bank_mask:0xf
    v_xor_b32_dpp v35, v35, v35 row_ror:1 row_mask:0xf bank_mask:0xf
    v_cndmask_b32 v32, v32, v33, s[0:1]
    v_cndmask_b32 v34, v34, v35, s[0:1]
    v_cndmask_b32 v11, v32, v34, s[90:91]
    v_cmp_eq_u32 vcc, v11, v12
    s_nop 0
    s_cmp_eq_u64 vcc, exec
    s_cbranch_scc1 RD_36
    s_add_u32 s5, s5, 1
    s_cmp_ge_u32 s5, 300000
    s_cbranch_scc1 RD_36
    s_sleep 1
    s_add_u32 s94, s96, 0
    buffer_load_dwordx4 v[64:67], v7, s[80:83], s94 offen sc0 sc1
    s_add_u32 s94, s96, 32768
    buffer_load_dwordx4 v[68:71], v7, s[80:83], s94 offen sc0 sc1
    s_add_u32 s94, s96, 65536
    buffer_load_dwordx4 v[72:75], v7, s[80:83], s94 offen sc0 sc1
    s_add_u32 s94, s96, 98304
    buffer_load_dwordx4 v[76:79], v7, s[80:83], s94 offen sc0 sc1
    s_waitcnt vmcnt(0)
    s_branch RC_35
RD_36:
    v_perm_b32 v84, v68, v64, s12
    v_perm_b32 v86, v68, v64, s13
    v_perm_b32 v85, v76, v72, s12
    v_perm_b32 v87, v76, v72, s13
    v_perm_b32 v88, v69, v65, s12
    v_perm_b32 v90, v69, v65, s13
    v_perm_b32 v89, v77, v73, s12
    v_perm_b32 v91, v77, v73, s13
    v_perm_b32 v92, v70, v66, s12
    v_perm_b32 v94, v70, v66, s13
    v_perm_b32 v93, v78, v74, s12
    v_perm_b32 v95, v78, v74, s13
    v_perm_b32 v96, v71, v67, s12
    v_perm_b32 v98, v71, v67, s13
    v_perm_b32 v97, v79, v75, s12
    v_perm_b32 v99, v79, v75, s13
EK_34:
    v_mfma_f32_16x16x16_bf16 v[100:103], v[52:53], v[84:85], 0
    v_mfma_f32_16x16x16_bf16 v[104:107], v[52:53], v[86:87], 0
    v_mfma_f32_16x16x16_bf16 v[108:111], v[52:53], v[88:89], 0
    v_mfma_f32_16x16x16_bf16 v[112:115], v[52:53], v[90:91], 0
    v_mfma_f32_16x16x16_bf16 v[116:119], v[52:53], v[92:93], 0
    v_mfma_f32_16x16x16_bf16 v[120:123], v[52:53], v[94:95], 0
    v_mfma_f32_16x16x16_bf16 v[124:127], v[52:53], v[96:97], 0
    v_mfma_f32_16x16x16_bf16 v[128:131], v[52:53], v[98:99], 0
    s_add_u32 s92, s6, 4
    s_and_b32 s92, s92, 31
    s_lshl_b32 s92, s92, 7
    s_lshl_b32 s93, s3, 4
    s_add_u32 s92, s92, s93
    s_mul_i32 s92, s92, 1152
    s_mul_i32 s93, s7, 288
    s_add_u32 s92, s92, s93
    s_mul_i32 s93, s3, 4608
    s_add_u32 m0, s93, 68608
    s_nop 0
    buffer_load_dwordx4 v195, s[60:63], s92 offen nt lds
    s_add_u32 m0, s93, 69632
    s_mov_b32 exec_lo, 0xffffffff
    s_mov_b32 exec_hi, 0x00000000
    buffer_load_dwordx4 v196, s[60:63], s92 offen nt lds
    s_mov_b64 exec, -1
    v_lshlrev_b32 v7, 8, v4
    v_lshl_add_u32 v7, v2, 3, v7
    s_lshl_b32 s94, s3, 5
    s_add_u32 s94, s94, 135168
    v_add_u32 v7, s94, v7
    v_and_b32 v14, 1, v3
    v_lshlrev_b32 v14, 8, v14
    v_lshl_add_u32 v14, v2, 4, v14
    v_add_u32 v14, 135168, v14
    v_and_b32 v15, 1, v3
    v_lshlrev_b32 v15, 10, v15
    v_lshrrev_b32 v13, 1, v3
    v_lshl_add_u32 v15, v13, 4, v15
    s_add_u32 s95, s4, 128
    s_lshl_b32 s95, s95, 11
    s_lshl_b32 s94, s3, 7
    s_add_u32 s95, s95, s94
    s_add_u32 s95, s95, 1048576
    v_mov_b32 v10, 0
    v_mov_b32 v11, 0.25
    v_cndmask_b32 v10, v10, v11, s[90:91]
    v_mov_b32 v11, s8
    s_mov_b32 exec_lo, 0x0000ffff
    s_mov_b32 exec_hi, 0x00000000
    ds_write2_b32 v5, v100, v104 offset0:0 offset1:1
    ds_write2_b32 v5, v108, v112 offset0:2 offset1:3
    ds_write2_b32 v5, v116, v120 offset0:4 offset1:5
    ds_write2_b32 v5, v124, v128 offset0:6 offset1:7
    s_mov_b64 exec, -1
    s_waitcnt lgkmcnt(0)
    s_barrier
    ds_read_b128 v[16:19], v6 offset:0
    ds_read_b128 v[20:23], v6 offset:512
    ds_read_b128 v[24:27], v6 offset:1024
    ds_read_b128 v[28:31], v6 offset:1536
    s_waitcnt lgkmcnt(0)
    v_add_f32 v16, v16, v20
    v_add_f32 v24, v24, v28
    v_add_f32 v17, v17, v21
    v_add_f32 v25, v25, v29
    v_add_f32 v18, v18, v22
    v_add_f32 v26, v26, v30
    v_add_f32 v19, v19, v23
    v_add_f32 v27, v27, v31
    v_add_f32 v16, v16, v24
    v_add_f32 v17, v17, v25
    v_add_f32 v18, v18, v26
    v_add_f32 v19, v19, v27
    v_cvt_pk_bf16_f32 v52, v16, v17
    v_cvt_pk_bf16_f32 v53, v18, v19
    s_mov_b32 exec_lo, 0x00110011
    s_mov_b32 exec_hi, 0x00110011
    ds_write_b64 v7, v[52:53]
    s_mov_b64 exec, -1
    s_waitcnt lgkmcnt(0)
    s_barrier
    ds_read_b128 v[16:19], v14 offset:0
    ds_read_b128 v[20:23], v14 offset:64
    ds_read_b128 v[24:27], v14 offset:128
    ds_read_b128 v[28:31], v14 offset:192
    s_waitcnt lgkmcnt(0)
    v_mfma_f32_16x16x32_bf16 v[64:67], v[16:19], v[164:167], 0
    v_mfma_f32_16x16x32_bf16 v[64:67], v[20:23], v[168:171], v[64:67]
    v_mfma_f32_16x16x32_bf16 v[64:67], v[24:27], v[172:175], v[64:67]
    v_mfma_f32_16x16x32_bf16 v[64:67], v[28:31], v[176:179], v[64:67]
    s_nop 7
    v_mov_b32_dpp v12, v64 quad_perm:[1,0,3,2] row_mask:0xf bank_mask:0xf
    v_mov_b32_dpp v13, v65 quad_perm:[1,0,3,2] row_mask:0xf bank_mask:0xf
    v_cndmask_b32 v8, v64, v13, s[0:1]
    v_cndmask_b32 v9, v12, v65, s[0:1]
    s_mov_b32 exec_lo, 0x0000ffff
    s_mov_b32 exec_hi, 0x00000000
    buffer_store_dwordx4 v[8:11], v15, s[80:83], s95 offen sc0 sc1
    s_mov_b64 exec, -1
    s_waitcnt vmcnt(1)
    s_barrier
    v_lshrrev_b32 v14, 2, v3
    v_lshlrev_b32 v14, 11, v14
    v_and_b32 v15, 1, v3
    v_lshl_add_u32 v14, v15, 10, v14
    v_lshl_add_u32 v14, v2, 5, v14
    v_and_b32 v13, 2, v3
    v_lshl_add_u32 v14, v13, 3, v14
    s_add_u32 s97, s6, 4
    s_and_b32 s97, s97, 31
    s_add_u32 s96, s97, 32
    s_lshl_b32 s96, s96, 13
    s_lshl_b32 s94, s3, 7
    s_add_u32 s96, s96, s94
    s_add_u32 s96, s96, 1048576
    buffer_load_dwordx4 v[48:51], v14, s[80:83], s96 offen sc0 sc1
    v_lshrrev_b32 v5, 1, v2
    v_mul_u32_u24 v5, 4608, v5
    v_and_b32 v6, 1, v2
    v_lshlrev_b32 v6, 3, v6
    v_lshrrev_b32 v7, 2, v3
    v_add_u32 v6, v6, v7
    v_mul_u32_u24 v6, 288, v6
    v_add_u32 v5, v5, v6
    v_and_b32 v6, 3, v3
    v_lshl_add_u32 v5, v6, 3, v5
    s_lshl_b32 s92, s3, 5
    s_add_u32 s92, s92, 65536
    v_add_u32 v5, s92, v5
    v_add_u32 v6, 18432, v5
    ds_read_b64_tr_b16 v[132:133], v5 offset:0
    ds_read_b64_tr_b16 v[134:135], v5 offset:1152
    ds_read_b64_tr_b16 v[136:137], v5 offset:9216
    ds_read_b64_tr_b16 v[138:139], v5 offset:10368
    ds_read_b64_tr_b16 v[140:141], v6 offset:0
    ds_read_b64_tr_b16 v[142:143], v6 offset:1152
    ds_read_b64_tr_b16 v[144:145], v6 offset:9216
    ds_read_b64_tr_b16 v[146:147], v6 offset:10368
    s_cmp_lg_u32 s3, 0
    s_cbranch_scc1 WX_37
    ds_read_b64_tr_b16 v[148:149], v5 offset:256
    ds_read_b64_tr_b16 v[150:151], v5 offset:1408
    ds_read_b64_tr_b16 v[152:153], v5 offset:9472
    ds_read_b64_tr_b16 v[154:155], v5 offset:10624
    ds_read_b64_tr_b16 v[156:157], v6 offset:256
    ds_read_b64_tr_b16 v[158:159], v6 offset:1408
    ds_read_b64_tr_b16 v[160:161], v6 offset:9472
    ds_read_b64_tr_b16 v[162:163], v6 offset:10624
WX_37:
    v_lshlrev_b32 v7, 8, v15
    v_lshl_add_u32 v7, v2, 3, v7
    v_lshl_add_u32 v7, v13, 1, v7
    s_lshl_b32 s94, s3, 5
    s_add_u32 s94, s94, 144384
    v_add_u32 v7, s94, v7
    v_and_b32 v6, 1, v3
    v_lshlrev_b32 v6, 8, v6
    v_lshl_add_u32 v6, v2, 4, v6
    v_add_u32 v6, 144384, v6
    v_mul_u32_u24 v15, 147456, v15
    v_lshrrev_b32 v13, 1, v3
    v_lshl_add_u32 v15, v13, 4, v15
    s_mul_i32 s98, s7, 36864
    s_lshl_b32 s94, s97, 7
    s_add_u32 s98, s98, s94
    s_add_u32 s98, s98, 6586368
    s_add_u32 s99, s98, 32768
    s_lshl_b32 s94, s3, 12
    s_add_u32 s98, s98, s94
    v_mov_b32 v105, s8
    v_mov_b32 v107, s8
    v_mov_b32 v109, s8
    v_mov_b32 v111, s8
    s_mov_b32 s5, 0
    s_waitcnt vmcnt(0)
RC_38:
    v_cmp_eq_u32 vcc, s8, v51
    s_nop 0
    s_cmp_eq_u64 vcc, exec
    s_cbranch_scc1 RD_39
    s_add_u32 s5, s5, 1
    s_cmp_ge_u32 s5, 300000
    s_cbranch_scc1 RD_39
    s_sleep 1
    buffer_load_dwordx4 v[48:51], v14, s[80:83], s96 offen sc0 sc1
    s_waitcnt vmcnt(0)
    s_branch RC_38
RD_39:
    v_mov_b32_dpp v9, v50 quad_perm:[2,3,0,1] row_mask:0xf bank_mask:0xf
    v_cndmask_b32 v8, v50, v9, s[90:91]
    v_cndmask_b32 v9, v9, v50, s[90:91]
    s_nop 0
    v_max_f32_dpp v10, v8, v8 row_ror:4 row_mask:0xf bank_mask:0xf
    s_nop 1
    v_max_f32_dpp v10, v10, v10 row_ror:8 row_mask:0xf bank_mask:0xf
    v_sub_f32 v8, v8, v10
    v_exp_f32 v8, v8
    s_nop 0
    v_mul_f32 v9, v8, v9
    v_mul_f32 v10, v8, v48
    v_mul_f32 v11, v8, v49
    v_add_f32_dpp v9, v9, v9 row_ror:4 row_mask:0xf bank_mask:0xf
    v_add_f32_dpp v10, v10, v10 row_ror:4 row_mask:0xf bank_mask:0xf
    v_add_f32_dpp v11, v11, v11 row_ror:4 row_mask:0xf bank_mask:0xf
    v_add_f32_dpp v9, v9, v9 row_ror:8 row_mask:0xf bank_mask:0xf
    v_add_f32_dpp v10, v10, v10 row_ror:8 row_mask:0xf bank_mask:0xf
    v_add_f32_dpp v11, v11, v11 row_ror:8 row_mask:0xf bank_mask:0xf
    v_rcp_f32 v9, v9
    s_nop 0
    v_mul_f32 v10, v10, v9
    v_mul_f32 v11, v11, v9
    v_cvt_pk_bf16_f32 v10, v10, v11
    s_mov_b32 exec_lo, 0x000f000f
    s_mov_b32 exec_hi, 0x000f000f
    ds_write_b32 v7, v10
    s_mov_b64 exec, -1
    s_waitcnt lgkmcnt(0)
    s_barrier
    ds_read_b128 v[16:19], v6 offset:0
    ds_read_b128 v[20:23], v6 offset:64
    ds_read_b128 v[24:27], v6 offset:128
    ds_read_b128 v[28:31], v6 offset:192
    s_waitcnt lgkmcnt(0)
    v_mfma_f32_16x16x32_bf16 v[64:67], v[16:19], v[132:135], 0
    v_mfma_f32_16x16x32_bf16 v[64:67], v[20:23], v[136:139], v[64:67]
    v_mfma_f32_16x16x32_bf16 v[64:67], v[24:27], v[140:143], v[64:67]
    v_mfma_f32_16x16x32_bf16 v[64:67], v[28:31], v[144:147], v[64:67]
    s_cmp_lg_u32 s3, 0
    s_nop 5
    s_cbranch_scc1 TO_40
    v_mfma_f32_16x16x32_bf16 v[68:71], v[16:19], v[148:151], 0
    v_mfma_f32_16x16x32_bf16 v[68:71], v[20:23], v[152:155], v[68:71]
    v_mfma_f32_16x16x32_bf16 v[68:71], v[24:27], v[156:159], v[68:71]
    v_mfma_f32_16x16x32_bf16 v[68:71], v[28:31], v[160:163], v[68:71]
    s_nop 7
    v_mov_b32_dpp v12, v68 quad_perm:[1,0,3,2] row_mask:0xf bank_mask:0xf
    v_mov_b32_dpp v13, v69 quad_perm:[1,0,3,2] row_mask:0xf bank_mask:0xf
    v_cndmask_b32 v108, v68, v13, s[0:1]
    v_cndmask_b32 v110, v12, v69, s[0:1]
    s_mov_b32 exec_lo, 0x0000ffff
    s_mov_b32 exec_hi, 0x00000000
    buffer_store_dwordx4 v[108:111], v15, s[80:83], s99 offen sc0 sc1
    s_mov_b64 exec, -1
TO_40:
    v_mov_b32_dpp v12, v64 quad_perm:[1,0,3,2] row_mask:0xf bank_mask:0xf
    v_mov_b32_dpp v13, v65 quad_perm:[1,0,3,2] row_mask:0xf bank_mask:0xf
    v_cndmask_b32 v104, v64, v13, s[0:1]
    v_cndmask_b32 v106, v12, v65, s[0:1]
    s_mov_b32 exec_lo, 0x0000ffff
    s_mov_b32 exec_hi, 0x00000000
    buffer_store_dwordx4 v[104:107], v15, s[80:83], s98 offen sc0 sc1
    s_mov_b64 exec, -1
    s_cmp_ge_u32 s4, 72
    s_cbranch_scc1 L_END
    s_cmp_lg_u32 s3, 0
    s_cbranch_scc1 L_END
    s_lshl_b32 s96, s4, 12
    s_add_u32 s96, s96, 6586368
    s_cmp_ge_u32 s4, 36
    s_cselect_b32 s94, 1152, 0
    s_lshl_b32 s95, s4, 5
    s_add_u32 s94, s94, s95
    s_add_u32 s100, s94, 1152
    v_lshlrev_b32 v5, 4, v1
    v_lshlrev_b32 v6, 2, v1
    buffer_load_dwordx4 v[16:19], v5, s[80:83], s96 offen offset:0 sc0 sc1
    buffer_load_dwordx4 v[20:23], v5, s[80:83], s96 offen offset:1024 sc0 sc1
    buffer_load_dwordx4 v[24:27], v5, s[80:83], s96 offen offset:2048 sc0 sc1
    buffer_load_dwordx4 v[28:31], v5, s[80:83], s96 offen offset:3072 sc0 sc1
    s_mov_b32 s5, 0
    s_sleep 10
    buffer_load_dwordx4 v[32:35], v5, s[80:83], s96 offen offset:0 sc0 sc1
    buffer_load_dwordx4 v[36:39], v5, s[80:83], s96 offen offset:1024 sc0 sc1
    buffer_load_dwordx4 v[40:43], v5, s[80:83], s96 offen offset:2048 sc0 sc1
    buffer_load_dwordx4 v[44:47], v5, s[80:83], s96 offen offset:3072 sc0 sc1
PP_41:
    s_waitcnt vmcnt(4)
    v_xor_b32 v8, s8, v17
    v_bitop3_b32 v8, v19, s8, v8 bitop3:0xbe
    v_bitop3_b32 v8, v21, s8, v8 bitop3:0xbe
    v_bitop3_b32 v8, v23, s8, v8 bitop3:0xbe
    v_bitop3_b32 v8, v25, s8, v8 bitop3:0xbe
    v_bitop3_b32 v8, v27, s8, v8 bitop3:0xbe
    v_bitop3_b32 v8, v29, s8, v8 bitop3:0xbe
    v_bitop3_b32 v8, v31, s8, v8 bitop3:0xbe
    v_cmp_eq_u32 vcc, 0, v8
    s_nop 0
    s_cmp_eq_u64 vcc, exec
    s_cbranch_scc1 PD_42
    buffer_load_dwordx4 v[16:19], v5, s[80:83], s96 offen offset:0 sc0 sc1
    buffer_load_dwordx4 v[20:23], v5, s[80:83], s96 offen offset:1024 sc0 sc1
    buffer_load_dwordx4 v[24:27], v5, s[80:83], s96 offen offset:2048 sc0 sc1
    buffer_load_dwordx4 v[28:31], v5, s[80:83], s96 offen offset:3072 sc0 sc1
    s_waitcnt vmcnt(4)
    v_xor_b32 v8, s8, v33
    v_bitop3_b32 v8, v35, s8, v8 bitop3:0xbe
    v_bitop3_b32 v8, v37, s8, v8 bitop3:0xbe
    v_bitop3_b32 v8, v39, s8, v8 bitop3:0xbe
    v_bitop3_b32 v8, v41, s8, v8 bitop3:0xbe
    v_bitop3_b32 v8, v43, s8, v8 bitop3:0xbe
    v_bitop3_b32 v8, v45, s8, v8 bitop3:0xbe
    v_bitop3_b32 v8, v47, s8, v8 bitop3:0xbe
    v_cmp_eq_u32 vcc, 0, v8
    s_nop 0
    s_cmp_eq_u64 vcc, exec
    s_cbranch_scc1 PD_43
    buffer_load_dwordx4 v[32:35], v5, s[80:83], s96 offen offset:0 sc0 sc1
    buffer_load_dwordx4 v[36:39], v5, s[80:83], s96 offen offset:1024 sc0 sc1
    buffer_load_dwordx4 v[40:43], v5, s[80:83], s96 offen offset:2048 sc0 sc1
    buffer_load_dwordx4 v[44:47], v5, s[80:83], s96 offen offset:3072 sc0 sc1
    s_add_u32 s5, s5, 1
    s_cmp_lt_u32 s5, 300000
    s_cbranch_scc1 PP_41
    s_waitcnt vmcnt(0)
PD_42:
    v_add_f32 v10, v16, v20
    v_add_f32 v11, v24, v28
    v_add_f32 v12, v18, v22
    v_add_f32 v13, v26, v30
    v_add_f32 v14, v10, v11
    v_add_f32 v15, v12, v13
    s_branch PE_44
PD_43:
    v_add_f32 v10, v32, v36
    v_add_f32 v11, v40, v44
    v_add_f32 v12, v34, v38
    v_add_f32 v13, v42, v46
    v_add_f32 v14, v10, v11
    v_add_f32 v15, v12, v13
PE_44:
    s_nop 0
    v_add_f32_dpp v14, v14, v14 row_ror:8 row_mask:0xf bank_mask:0xf
    v_add_f32_dpp v15, v15, v15 row_ror:8 row_mask:0xf bank_mask:0xf
    v_mov_b32 v8, v14
    v_mov_b32 v9, v15
    s_nop 0
    v_permlane16_swap_b32 v14, v8
    v_permlane16_swap_b32 v15, v9
    v_add_f32 v14, v14, v8
    v_add_f32 v15, v15, v9
    v_mov_b32 v8, v14
    v_mov_b32 v9, v15
    s_nop 0
    v_permlane32_swap_b32 v14, v8
    v_permlane32_swap_b32 v15, v9
    v_add_f32 v14, v14, v8
    v_add_f32 v15, v15, v9
    v_cvt_pk_bf16_f32 v14, v14, v15
    s_mov_b32 exec_lo, 0x000000ff
    s_mov_b32 exec_hi, 0x00000000
    buffer_store_dword v14, v6, s[84:87], s100 offen
    s_mov_b64 exec, -1
    s_waitcnt vmcnt(0)
    s_branch L_END
L_END:
L_EXIT:
    s_endpgm
.section .rodata,"a"
.p2align 6
.amdhsa_kernel concat_heads__sliding_block_cached__compressed_kv_cla__decode_kernel
  .amdhsa_next_free_vgpr 256
  .amdhsa_next_free_sgpr 102
  .amdhsa_accum_offset 256
  .amdhsa_group_segment_fixed_size 0
  .amdhsa_kernarg_size 112
  .amdhsa_user_sgpr_count 2
  .amdhsa_user_sgpr_kernarg_segment_ptr 1
  .amdhsa_system_sgpr_workgroup_id_x 1
.end_amdhsa_kernel
```
